```python
import torch

def _softmax(x, axis=-1):
    return torch.softmax(x, dim=axis)
def _gelu(x):
    return torch.nn.functional.gelu(x, approximate="tanh")
def _silu(x):
    return torch.nn.functional.silu(x)
def _sigmoid(x):
    return torch.sigmoid(x)
def _layernorm(x, axis=-1, eps=1e-5):
    m = x.mean(dim=axis, keepdim=True)
    v = x.var(dim=axis, keepdim=True, unbiased=False)
    return (x - m) / torch.sqrt(v + eps)
def _scatter_add(tgt, idx, src, axis=0):
    return tgt.clone().index_add_(axis, idx, src)
def _segment_sum(src, seg, n):
    out = torch.zeros((n,) + src.shape[1:], dtype=src.dtype)
    return out.index_add_(0, seg, src)
def _pad(x, pw):
    flat = tuple(v for pair in reversed(pw) for v in pair)
    return torch.nn.functional.pad(x, flat)

kernel_name = 'concat_heads__mha_block__ssm_conv_s4__prompt'

def setup_inputs():

    _w = (lambda a: (lambda t: t.to(torch.bfloat16) if t.is_floating_point() else t)(torch.as_tensor(a)))
    def _A_setup():
        B, S, D, H = 1, 2048, 640, 32
        return {
            "x": _w((lambda *s: torch.randn(*s, dtype=torch.bfloat16) * 0.2)(B, S, D)),
            "wqkv": _w((lambda *s: torch.randn(*s, dtype=torch.bfloat16) * 0.2)(D, 3 * D)),
            "wo": _w((lambda *s: torch.randn(*s, dtype=torch.bfloat16) * 0.05)(D, D)),
        }
    _A_in = _A_setup()

    def _B_setup():
        B, L, D, N = 1, 2048, 640, 128
        A_re = -(lambda _x: torch.exp(torch.as_tensor(_x)))((lambda *s: torch.randn(*s, dtype=torch.bfloat16) * 3.2)(D, N))
        A_im = torch.pi * (lambda *s: torch.randn(*s, dtype=torch.bfloat16) * 0.1)(D, N)
        B_re = (lambda *s: torch.randn(*s, dtype=torch.bfloat16) * 0.4)(D, N)
        B_im = (lambda *s: torch.randn(*s, dtype=torch.bfloat16) * 0.4)(D, N)
        C_re = (lambda *s: torch.randn(*s, dtype=torch.bfloat16) * 0.4)(D, N)
        C_im = (lambda *s: torch.randn(*s, dtype=torch.bfloat16) * 0.4)(D, N)
        log_dt = (lambda *s: torch.randn(*s, dtype=torch.bfloat16) * 0.1)(D) * 0.5 - 4.0
        Dskip = (lambda *s: torch.randn(*s, dtype=torch.bfloat16) * 0.2)(D)
        return {
            "u": _w((lambda *s: torch.randn(*s, dtype=torch.bfloat16) * 0.05)(B, L, D)),
            "A_re": _w(A_re),
            "A_im": _w(A_im),
            "B_re": _w(B_re),
            "B_im": _w(B_im),
            "C_re": _w(C_re),
            "C_im": _w(C_im),
            "log_dt": _w(log_dt),
            "Dskip": _w(Dskip),
        }
    _B_in = _B_setup()

    return {
        "A_x": _A_in["x"],
        "A_wqkv": _A_in["wqkv"],
        "A_wo": _A_in["wo"],
        "B_u": _B_in["u"],
        "B_A_re": _B_in["A_re"],
        "B_A_im": _B_in["A_im"],
        "B_B_re": _B_in["B_re"],
        "B_B_im": _B_in["B_im"],
        "B_C_re": _B_in["C_re"],
        "B_C_im": _B_in["C_im"],
        "B_log_dt": _B_in["log_dt"],
        "B_Dskip": _B_in["Dskip"],
    }

def reference(A_x, A_wqkv, A_wo, B_u, B_A_re, B_A_im, B_B_re, B_B_im, B_C_re, B_C_im, B_log_dt, B_Dskip):
    def _A_ref(x, wqkv, wo):
        B, S, D = x.shape
        H = 32
        Dh = D // H
        qkv = (lambda x, *d: x.permute(*d))((x @ wqkv).reshape(B, S, 3, H, Dh), 2, 0, 3, 1, 4)
        q, k, v = qkv[0], qkv[1], qkv[2]
        scores = torch.einsum("bhqd,bhkd->bhqk", q, k) * (Dh ** -0.5)
        p = _softmax(scores, axis=-1)
        o = torch.einsum("bhqk,bhkd->bhqd", p, v)
        return (lambda x, *d: x.permute(*d))(o, 0, 2, 1, 3).reshape(B, S, D) @ wo

    def _B_ref(u, A_re, A_im, B_re, B_im, C_re, C_im, log_dt, Dskip):
        Bsz, L, D = u.shape
        dt = torch.exp(log_dt)[:, None]
        A = A_re + 1j * A_im
        Bc = B_re + 1j * B_im
        Cc = C_re + 1j * C_im
        logdA = dt * A
        dB = dt * Bc
        l = (lambda x, dt: x.to(dt))(torch.arange(L), A_re.dtype)
        P = torch.exp(logdA[:, :, None] * l[None, None, :])
        K = torch.einsum("dn,dnl,dn->dl", Cc, P, dB).real
        L2 = 2 * L
        Kp = _pad(K, ((0, 0), (0, L)))
        up = (lambda x, *d: x.permute(*d))(u, 0, 2, 1)
        up = _pad(up, ((0, 0), (0, 0), (0, L)))
        Kf = (lambda x, axes=(-2,-1): torch.fft.rfft2(x.float(), dim=axes))(Kp[:, None, :], axes=(-2, -1))
        Uf = (lambda x, axes=(-2,-1): torch.fft.rfft2(x.float(), dim=axes))(up[:, :, None, :], axes=(-2, -1))
        Yf = Uf * Kf[None, :, :, :]
        y = (lambda x, s, axes=(-2,-1): torch.fft.irfft2(x, s=s, dim=axes).to(torch.bfloat16))(Yf, (1, L2), axes=(-2, -1))[:, :, 0, :L]
        y = (lambda x, *d: x.permute(*d))(y, 0, 2, 1) + u * Dskip[None, None, :]
        return y

    a = _A_ref(A_x, A_wqkv, A_wo)
    b = _B_ref(B_u, B_A_re, B_A_im, B_B_re, B_B_im, B_C_re, B_C_im, B_log_dt, B_Dskip)
    return torch.concatenate([a, b], axis=-1)
```

```asm
; @launch kernel=k1_kernel grid=(256,1,1) block=(512,1,1) lds=163840
; @launch kernel=k2_kernel grid=(512,1,1) block=(512,1,1) lds=81920
.amdgcn_target "amdgcn-amd-amdhsa--gfx950"
.text
.globl k1_kernel
.p2align 8
.type k1_kernel,@function
k1_kernel:
    s_load_dwordx4 s[4:7], s[0:1], 0
    s_load_dwordx2 s[34:35], s[0:1], 112
    s_cmp_ge_u32 s2, 256
    s_cbranch_scc1 G_exit
    v_lshrrev_b32 v1, 6, v0
    v_and_b32 v2, 63, v0
    s_and_b32 s3, s2, 7
    v_readfirstlane_b32 s16, v1
    s_lshr_b32 s24, s2, 3
    s_and_b32 s17, s3, 3
    s_lshl_b32 s17, s17, 2
    s_and_b32 s25, s24, 3
    s_add_u32 s17, s17, s25
    s_lshr_b32 s18, s3, 2
    s_lshl_b32 s18, s18, 3
    s_lshr_b32 s25, s24, 2
    s_add_u32 s18, s18, s25
    s_cmp_eq_u32 s18, 15
    s_cbranch_scc1 SP_entry
    s_cmp_lt_u32 s16, 2
    s_cbranch_scc1 L_entry
    s_cmp_lt_u32 s16, 4
    s_cbranch_scc1 KG_entry
    s_sub_u32 s16, s16, 4
    s_setprio 2
    v_lshrrev_b32 v3, 5, v2
    v_and_b32 v4, 31, v2
    v_and_b32 v100, 0x13, v4
    v_bfe_u32 v101, v4, 2, 1
    v_lshl_or_b32 v100, v101, 3, v100
    v_bfe_u32 v101, v4, 3, 1
    v_lshl_or_b32 v100, v101, 2, v100
    s_lshl_b32 s26, s16, 12
    s_add_u32 s26, s26, 65536
    v_lshl_add_u32 v101, v100, 7, s26
    v_bfe_u32 v102, v100, 1, 3
    v_xor_b32 v102, v102, v3
    v_xor_b32 v103, 0, v102
    v_lshl_add_u32 v8, v103, 4, v101
    v_xor_b32 v103, 2, v102
    v_lshl_add_u32 v9, v103, 4, v101
    v_xor_b32 v103, 4, v102
    v_lshl_add_u32 v10, v103, 4, v101
    v_xor_b32 v103, 6, v102
    v_lshl_add_u32 v11, v103, 4, v101
    v_bfe_u32 v101, v2, 2, 2
    v_lshl_add_u32 v102, v3, 3, v101
    v_lshlrev_b32 v102, 7, v102
    v_bfe_u32 v103, v2, 4, 1
    v_lshl_add_u32 v102, v103, 5, v102
    v_and_b32 v103, 1, v2
    v_lshl_add_u32 v102, v103, 4, v102
    v_bfe_u32 v103, v2, 1, 1
    v_lshl_add_u32 v102, v103, 3, v102
    v_bfe_u32 v103, v2, 3, 1
    v_lshl_add_u32 v102, v103, 6, v102
    v_add_u32 v12, 98304, v102
    v_add_u32 v14, 40960, v102
    v_xor_b32 v13, 64, v12
    v_xor_b32 v15, 64, v14
    s_lshl_b32 s28, s17, 2
    s_add_u32 s28, s28, s16
    s_mul_i32 s33, s28, 123008
    s_add_u32 s31, s33, 122880
    s_lshl_b32 s26, s18, 13
    s_add_u32 s33, s33, s26
    s_add_u32 s33, s33, 0
    s_add_u32 s30, s33, 4096
    v_lshlrev_b32 v16, 4, v100
    v_lshl_add_u32 v16, v3, 9, v16
    s_cmp_ge_u32 s18, 5
    s_cselect_b32 s32, 1.0, 0x3ea52b5c
    s_cmp_ge_u32 s18, 10
    s_cbranch_scc1 G_vsetup
    s_barrier
    ds_read_b128 v[96:99], v8 offset:0
    ds_read_b64_tr_b16 v[24:25], v12 offset:32768
    ds_read_b64_tr_b16 v[26:27], v12 offset:33280
    ds_read_b64_tr_b16 v[28:29], v13 offset:32768
    ds_read_b64_tr_b16 v[30:31], v13 offset:33280
    ds_read_b128 v[100:103], v9 offset:0
    ds_read_b64_tr_b16 v[32:33], v12 offset:34816
    ds_read_b64_tr_b16 v[34:35], v12 offset:35328
    ds_read_b64_tr_b16 v[36:37], v13 offset:34816
    ds_read_b64_tr_b16 v[38:39], v13 offset:35328
    ds_read_b128 v[104:107], v10 offset:0
    ds_read_b64_tr_b16 v[80:81], v12 offset:36864
    ds_read_b64_tr_b16 v[82:83], v12 offset:37376
    ds_read_b64_tr_b16 v[84:85], v13 offset:36864
    ds_read_b64_tr_b16 v[86:87], v13 offset:37376
    ds_read_b128 v[108:111], v11 offset:0
    ds_read_b64_tr_b16 v[88:89], v12 offset:38912
    ds_read_b64_tr_b16 v[90:91], v12 offset:39424
    ds_read_b64_tr_b16 v[92:93], v13 offset:38912
    ds_read_b64_tr_b16 v[94:95], v13 offset:39424
    s_waitcnt lgkmcnt(15)
    v_mfma_f32_32x32x16_bf16 v[48:63], v[24:27], v[96:99], 0
    v_mfma_f32_32x32x16_bf16 v[64:79], v[28:31], v[96:99], 0
    s_waitcnt lgkmcnt(10)
    v_mfma_f32_32x32x16_bf16 v[48:63], v[32:35], v[100:103], v[48:63]
    v_mfma_f32_32x32x16_bf16 v[64:79], v[36:39], v[100:103], v[64:79]
    s_waitcnt lgkmcnt(0)
    s_mov_b32 s36, s34
    s_mov_b32 s37, s35
    s_mov_b32 s38, 0x2000000
    s_mov_b32 s39, 0x00020000
    s_barrier
    ds_read_b128 v[112:115], v8 offset:16384
    ds_read_b64_tr_b16 v[24:25], v12 offset:40960
    ds_read_b64_tr_b16 v[26:27], v12 offset:41472
    ds_read_b64_tr_b16 v[28:29], v13 offset:40960
    ds_read_b64_tr_b16 v[30:31], v13 offset:41472
    ds_read_b128 v[116:119], v9 offset:16384
    ds_read_b64_tr_b16 v[32:33], v12 offset:43008
    ds_read_b64_tr_b16 v[34:35], v12 offset:43520
    ds_read_b64_tr_b16 v[36:37], v13 offset:43008
    ds_read_b64_tr_b16 v[38:39], v13 offset:43520
    v_mfma_f32_32x32x16_bf16 v[48:63], v[80:83], v[104:107], v[48:63]
    v_mfma_f32_32x32x16_bf16 v[64:79], v[84:87], v[104:107], v[64:79]
    ds_read_b128 v[120:123], v10 offset:16384
    ds_read_b64_tr_b16 v[80:81], v12 offset:45056
    ds_read_b64_tr_b16 v[82:83], v12 offset:45568
    ds_read_b64_tr_b16 v[84:85], v13 offset:45056
    ds_read_b64_tr_b16 v[86:87], v13 offset:45568
    v_mfma_f32_32x32x16_bf16 v[48:63], v[88:91], v[108:111], v[48:63]
    v_mfma_f32_32x32x16_bf16 v[64:79], v[92:95], v[108:111], v[64:79]
    ds_read_b128 v[124:127], v11 offset:16384
    ds_read_b64_tr_b16 v[88:89], v12 offset:47104
    ds_read_b64_tr_b16 v[90:91], v12 offset:47616
    ds_read_b64_tr_b16 v[92:93], v13 offset:47104
    ds_read_b64_tr_b16 v[94:95], v13 offset:47616
    s_waitcnt lgkmcnt(15)
    v_mfma_f32_32x32x16_bf16 v[48:63], v[24:27], v[112:115], v[48:63]
    v_mfma_f32_32x32x16_bf16 v[64:79], v[28:31], v[112:115], v[64:79]
    s_waitcnt lgkmcnt(10)
    v_mfma_f32_32x32x16_bf16 v[48:63], v[32:35], v[116:119], v[48:63]
    v_mfma_f32_32x32x16_bf16 v[64:79], v[36:39], v[116:119], v[64:79]
    s_waitcnt lgkmcnt(0)
    s_barrier
    ds_read_b128 v[128:131], v8 offset:32768
    ds_read_b64_tr_b16 v[24:25], v12 offset:49152
    ds_read_b64_tr_b16 v[26:27], v12 offset:49664
    ds_read_b64_tr_b16 v[28:29], v13 offset:49152
    ds_read_b64_tr_b16 v[30:31], v13 offset:49664
    ds_read_b128 v[132:135], v9 offset:32768
    ds_read_b64_tr_b16 v[32:33], v12 offset:51200
    ds_read_b64_tr_b16 v[34:35], v12 offset:51712
    ds_read_b64_tr_b16 v[36:37], v13 offset:51200
    ds_read_b64_tr_b16 v[38:39], v13 offset:51712
    v_mfma_f32_32x32x16_bf16 v[48:63], v[80:83], v[120:123], v[48:63]
    v_mfma_f32_32x32x16_bf16 v[64:79], v[84:87], v[120:123], v[64:79]
    ds_read_b128 v[136:139], v10 offset:32768
    ds_read_b64_tr_b16 v[80:81], v12 offset:53248
    ds_read_b64_tr_b16 v[82:83], v12 offset:53760
    ds_read_b64_tr_b16 v[84:85], v13 offset:53248
    ds_read_b64_tr_b16 v[86:87], v13 offset:53760
    v_mfma_f32_32x32x16_bf16 v[48:63], v[88:91], v[124:127], v[48:63]
    v_mfma_f32_32x32x16_bf16 v[64:79], v[92:95], v[124:127], v[64:79]
    ds_read_b128 v[140:143], v11 offset:32768
    ds_read_b64_tr_b16 v[88:89], v12 offset:55296
    ds_read_b64_tr_b16 v[90:91], v12 offset:55808
    ds_read_b64_tr_b16 v[92:93], v13 offset:55296
    ds_read_b64_tr_b16 v[94:95], v13 offset:55808
    s_waitcnt lgkmcnt(15)
    v_mfma_f32_32x32x16_bf16 v[48:63], v[24:27], v[128:131], v[48:63]
    v_mfma_f32_32x32x16_bf16 v[64:79], v[28:31], v[128:131], v[64:79]
    s_waitcnt lgkmcnt(10)
    v_mfma_f32_32x32x16_bf16 v[48:63], v[32:35], v[132:135], v[48:63]
    v_mfma_f32_32x32x16_bf16 v[64:79], v[36:39], v[132:135], v[64:79]
    s_waitcnt lgkmcnt(0)
    s_barrier
    ds_read_b128 v[144:147], v8 offset:49152
    ds_read_b64_tr_b16 v[24:25], v12 offset:57344
    ds_read_b64_tr_b16 v[26:27], v12 offset:57856
    ds_read_b64_tr_b16 v[28:29], v13 offset:57344
    ds_read_b64_tr_b16 v[30:31], v13 offset:57856
    ds_read_b128 v[148:151], v9 offset:49152
    ds_read_b64_tr_b16 v[32:33], v12 offset:59392
    ds_read_b64_tr_b16 v[34:35], v12 offset:59904
    ds_read_b64_tr_b16 v[36:37], v13 offset:59392
    ds_read_b64_tr_b16 v[38:39], v13 offset:59904
    v_mfma_f32_32x32x16_bf16 v[48:63], v[80:83], v[136:139], v[48:63]
    v_mfma_f32_32x32x16_bf16 v[64:79], v[84:87], v[136:139], v[64:79]
    ds_read_b128 v[152:155], v10 offset:49152
    ds_read_b64_tr_b16 v[80:81], v12 offset:61440
    ds_read_b64_tr_b16 v[82:83], v12 offset:61952
    ds_read_b64_tr_b16 v[84:85], v13 offset:61440
    ds_read_b64_tr_b16 v[86:87], v13 offset:61952
    v_mfma_f32_32x32x16_bf16 v[48:63], v[88:91], v[140:143], v[48:63]
    v_mfma_f32_32x32x16_bf16 v[64:79], v[92:95], v[140:143], v[64:79]
    ds_read_b128 v[156:159], v11 offset:49152
    ds_read_b64_tr_b16 v[88:89], v12 offset:63488
    ds_read_b64_tr_b16 v[90:91], v12 offset:64000
    ds_read_b64_tr_b16 v[92:93], v13 offset:63488
    ds_read_b64_tr_b16 v[94:95], v13 offset:64000
    s_waitcnt lgkmcnt(15)
    v_mfma_f32_32x32x16_bf16 v[48:63], v[24:27], v[144:147], v[48:63]
    v_mfma_f32_32x32x16_bf16 v[64:79], v[28:31], v[144:147], v[64:79]
    s_waitcnt lgkmcnt(10)
    v_mfma_f32_32x32x16_bf16 v[48:63], v[32:35], v[148:151], v[48:63]
    v_mfma_f32_32x32x16_bf16 v[64:79], v[36:39], v[148:151], v[64:79]
    s_waitcnt lgkmcnt(0)
    s_barrier
    ds_read_b128 v[160:163], v8 offset:0
    ds_read_b64_tr_b16 v[24:25], v12 offset:32768
    ds_read_b64_tr_b16 v[26:27], v12 offset:33280
    ds_read_b64_tr_b16 v[28:29], v13 offset:32768
    ds_read_b64_tr_b16 v[30:31], v13 offset:33280
    ds_read_b128 v[164:167], v9 offset:0
    ds_read_b64_tr_b16 v[32:33], v12 offset:34816
    ds_read_b64_tr_b16 v[34:35], v12 offset:35328
    ds_read_b64_tr_b16 v[36:37], v13 offset:34816
    ds_read_b64_tr_b16 v[38:39], v13 offset:35328
    v_mfma_f32_32x32x16_bf16 v[48:63], v[80:83], v[152:155], v[48:63]
    v_mfma_f32_32x32x16_bf16 v[64:79], v[84:87], v[152:155], v[64:79]
    ds_read_b128 v[168:171], v10 offset:0
    ds_read_b64_tr_b16 v[80:81], v12 offset:36864
    ds_read_b64_tr_b16 v[82:83], v12 offset:37376
    ds_read_b64_tr_b16 v[84:85], v13 offset:36864
    ds_read_b64_tr_b16 v[86:87], v13 offset:37376
    v_mfma_f32_32x32x16_bf16 v[48:63], v[88:91], v[156:159], v[48:63]
    v_mfma_f32_32x32x16_bf16 v[64:79], v[92:95], v[156:159], v[64:79]
    ds_read_b128 v[172:175], v11 offset:0
    ds_read_b64_tr_b16 v[88:89], v12 offset:38912
    ds_read_b64_tr_b16 v[90:91], v12 offset:39424
    ds_read_b64_tr_b16 v[92:93], v13 offset:38912
    ds_read_b64_tr_b16 v[94:95], v13 offset:39424
    s_waitcnt lgkmcnt(15)
    v_mfma_f32_32x32x16_bf16 v[48:63], v[24:27], v[160:163], v[48:63]
    v_mfma_f32_32x32x16_bf16 v[64:79], v[28:31], v[160:163], v[64:79]
    s_waitcnt lgkmcnt(10)
    v_mfma_f32_32x32x16_bf16 v[48:63], v[32:35], v[164:167], v[48:63]
    v_mfma_f32_32x32x16_bf16 v[64:79], v[36:39], v[164:167], v[64:79]
    s_waitcnt lgkmcnt(0)
    s_barrier
    ds_read_b128 v[176:179], v8 offset:16384
    ds_read_b64_tr_b16 v[24:25], v12 offset:40960
    ds_read_b64_tr_b16 v[26:27], v12 offset:41472
    ds_read_b64_tr_b16 v[28:29], v13 offset:40960
    ds_read_b64_tr_b16 v[30:31], v13 offset:41472
    ds_read_b128 v[180:183], v9 offset:16384
    ds_read_b64_tr_b16 v[32:33], v12 offset:43008
    ds_read_b64_tr_b16 v[34:35], v12 offset:43520
    ds_read_b64_tr_b16 v[36:37], v13 offset:43008
    ds_read_b64_tr_b16 v[38:39], v13 offset:43520
    v_mfma_f32_32x32x16_bf16 v[48:63], v[80:83], v[168:171], v[48:63]
    v_mfma_f32_32x32x16_bf16 v[64:79], v[84:87], v[168:171], v[64:79]
    ds_read_b128 v[184:187], v10 offset:16384
    ds_read_b64_tr_b16 v[80:81], v12 offset:45056
    ds_read_b64_tr_b16 v[82:83], v12 offset:45568
    ds_read_b64_tr_b16 v[84:85], v13 offset:45056
    ds_read_b64_tr_b16 v[86:87], v13 offset:45568
    v_mfma_f32_32x32x16_bf16 v[48:63], v[88:91], v[172:175], v[48:63]
    v_mfma_f32_32x32x16_bf16 v[64:79], v[92:95], v[172:175], v[64:79]
    ds_read_b128 v[188:191], v11 offset:16384
    ds_read_b64_tr_b16 v[88:89], v12 offset:47104
    ds_read_b64_tr_b16 v[90:91], v12 offset:47616
    ds_read_b64_tr_b16 v[92:93], v13 offset:47104
    ds_read_b64_tr_b16 v[94:95], v13 offset:47616
    s_waitcnt lgkmcnt(15)
    v_mfma_f32_32x32x16_bf16 v[48:63], v[24:27], v[176:179], v[48:63]
    v_mfma_f32_32x32x16_bf16 v[64:79], v[28:31], v[176:179], v[64:79]
    s_waitcnt lgkmcnt(10)
    v_mfma_f32_32x32x16_bf16 v[48:63], v[32:35], v[180:183], v[48:63]
    v_mfma_f32_32x32x16_bf16 v[64:79], v[36:39], v[180:183], v[64:79]
    s_waitcnt lgkmcnt(0)
    s_barrier
    ds_read_b128 v[192:195], v8 offset:32768
    ds_read_b64_tr_b16 v[24:25], v12 offset:49152
    ds_read_b64_tr_b16 v[26:27], v12 offset:49664
    ds_read_b64_tr_b16 v[28:29], v13 offset:49152
    ds_read_b64_tr_b16 v[30:31], v13 offset:49664
    ds_read_b128 v[196:199], v9 offset:32768
    ds_read_b64_tr_b16 v[32:33], v12 offset:51200
    ds_read_b64_tr_b16 v[34:35], v12 offset:51712
    ds_read_b64_tr_b16 v[36:37], v13 offset:51200
    ds_read_b64_tr_b16 v[38:39], v13 offset:51712
    v_mfma_f32_32x32x16_bf16 v[48:63], v[80:83], v[184:187], v[48:63]
    v_mfma_f32_32x32x16_bf16 v[64:79], v[84:87], v[184:187], v[64:79]
    ds_read_b128 v[200:203], v10 offset:32768
    ds_read_b64_tr_b16 v[80:81], v12 offset:53248
    ds_read_b64_tr_b16 v[82:83], v12 offset:53760
    ds_read_b64_tr_b16 v[84:85], v13 offset:53248
    ds_read_b64_tr_b16 v[86:87], v13 offset:53760
    v_mfma_f32_32x32x16_bf16 v[48:63], v[88:91], v[188:191], v[48:63]
    v_mfma_f32_32x32x16_bf16 v[64:79], v[92:95], v[188:191], v[64:79]
    ds_read_b128 v[204:207], v11 offset:32768
    ds_read_b64_tr_b16 v[88:89], v12 offset:55296
    ds_read_b64_tr_b16 v[90:91], v12 offset:55808
    ds_read_b64_tr_b16 v[92:93], v13 offset:55296
    ds_read_b64_tr_b16 v[94:95], v13 offset:55808
    s_waitcnt lgkmcnt(15)
    v_mfma_f32_32x32x16_bf16 v[48:63], v[24:27], v[192:195], v[48:63]
    v_mfma_f32_32x32x16_bf16 v[64:79], v[28:31], v[192:195], v[64:79]
    s_waitcnt lgkmcnt(10)
    v_mfma_f32_32x32x16_bf16 v[48:63], v[32:35], v[196:199], v[48:63]
    v_mfma_f32_32x32x16_bf16 v[64:79], v[36:39], v[196:199], v[64:79]
    s_waitcnt lgkmcnt(0)
    s_barrier
    ds_read_b128 v[208:211], v8 offset:49152
    ds_read_b64_tr_b16 v[24:25], v12 offset:57344
    ds_read_b64_tr_b16 v[26:27], v12 offset:57856
    ds_read_b64_tr_b16 v[28:29], v13 offset:57344
    ds_read_b64_tr_b16 v[30:31], v13 offset:57856
    ds_read_b128 v[212:215], v9 offset:49152
    ds_read_b64_tr_b16 v[32:33], v12 offset:59392
    ds_read_b64_tr_b16 v[34:35], v12 offset:59904
    ds_read_b64_tr_b16 v[36:37], v13 offset:59392
    ds_read_b64_tr_b16 v[38:39], v13 offset:59904
    v_mfma_f32_32x32x16_bf16 v[48:63], v[80:83], v[200:203], v[48:63]
    v_mfma_f32_32x32x16_bf16 v[64:79], v[84:87], v[200:203], v[64:79]
    ds_read_b128 v[216:219], v10 offset:49152
    ds_read_b64_tr_b16 v[80:81], v12 offset:61440
    ds_read_b64_tr_b16 v[82:83], v12 offset:61952
    ds_read_b64_tr_b16 v[84:85], v13 offset:61440
    ds_read_b64_tr_b16 v[86:87], v13 offset:61952
    v_mfma_f32_32x32x16_bf16 v[48:63], v[88:91], v[204:207], v[48:63]
    v_mfma_f32_32x32x16_bf16 v[64:79], v[92:95], v[204:207], v[64:79]
    ds_read_b128 v[220:223], v11 offset:49152
    ds_read_b64_tr_b16 v[88:89], v12 offset:63488
    ds_read_b64_tr_b16 v[90:91], v12 offset:64000
    ds_read_b64_tr_b16 v[92:93], v13 offset:63488
    ds_read_b64_tr_b16 v[94:95], v13 offset:64000
    s_waitcnt lgkmcnt(15)
    v_mfma_f32_32x32x16_bf16 v[48:63], v[24:27], v[208:211], v[48:63]
    v_mfma_f32_32x32x16_bf16 v[64:79], v[28:31], v[208:211], v[64:79]
    s_waitcnt lgkmcnt(10)
    v_mfma_f32_32x32x16_bf16 v[48:63], v[32:35], v[212:215], v[48:63]
    v_mfma_f32_32x32x16_bf16 v[64:79], v[36:39], v[212:215], v[64:79]
    s_waitcnt lgkmcnt(0)
    s_barrier
    ds_read_b128 v[224:227], v8 offset:0
    ds_read_b64_tr_b16 v[24:25], v12 offset:32768
    ds_read_b64_tr_b16 v[26:27], v12 offset:33280
    ds_read_b64_tr_b16 v[28:29], v13 offset:32768
    ds_read_b64_tr_b16 v[30:31], v13 offset:33280
    ds_read_b128 v[228:231], v9 offset:0
    ds_read_b64_tr_b16 v[32:33], v12 offset:34816
    ds_read_b64_tr_b16 v[34:35], v12 offset:35328
    ds_read_b64_tr_b16 v[36:37], v13 offset:34816
    ds_read_b64_tr_b16 v[38:39], v13 offset:35328
    v_mfma_f32_32x32x16_bf16 v[48:63], v[80:83], v[216:219], v[48:63]
    v_mfma_f32_32x32x16_bf16 v[64:79], v[84:87], v[216:219], v[64:79]
    ds_read_b128 v[232:235], v10 offset:0
    ds_read_b64_tr_b16 v[80:81], v12 offset:36864
    ds_read_b64_tr_b16 v[82:83], v12 offset:37376
    ds_read_b64_tr_b16 v[84:85], v13 offset:36864
    ds_read_b64_tr_b16 v[86:87], v13 offset:37376
    v_mfma_f32_32x32x16_bf16 v[48:63], v[88:91], v[220:223], v[48:63]
    v_mfma_f32_32x32x16_bf16 v[64:79], v[92:95], v[220:223], v[64:79]
    ds_read_b128 v[236:239], v11 offset:0
    ds_read_b64_tr_b16 v[88:89], v12 offset:38912
    ds_read_b64_tr_b16 v[90:91], v12 offset:39424
    ds_read_b64_tr_b16 v[92:93], v13 offset:38912
    ds_read_b64_tr_b16 v[94:95], v13 offset:39424
    s_waitcnt lgkmcnt(15)
    v_mfma_f32_32x32x16_bf16 v[48:63], v[24:27], v[224:227], v[48:63]
    v_mfma_f32_32x32x16_bf16 v[64:79], v[28:31], v[224:227], v[64:79]
    s_waitcnt lgkmcnt(10)
    v_mfma_f32_32x32x16_bf16 v[48:63], v[32:35], v[228:231], v[48:63]
    v_mfma_f32_32x32x16_bf16 v[64:79], v[36:39], v[228:231], v[64:79]
    s_waitcnt lgkmcnt(0)
    s_barrier
    ds_read_b128 v[240:243], v8 offset:16384
    ds_read_b64_tr_b16 v[24:25], v12 offset:40960
    ds_read_b64_tr_b16 v[26:27], v12 offset:41472
    ds_read_b64_tr_b16 v[28:29], v13 offset:40960
    ds_read_b64_tr_b16 v[30:31], v13 offset:41472
    ds_read_b128 v[244:247], v9 offset:16384
    ds_read_b64_tr_b16 v[32:33], v12 offset:43008
    ds_read_b64_tr_b16 v[34:35], v12 offset:43520
    ds_read_b64_tr_b16 v[36:37], v13 offset:43008
    ds_read_b64_tr_b16 v[38:39], v13 offset:43520
    v_mfma_f32_32x32x16_bf16 v[48:63], v[80:83], v[232:235], v[48:63]
    v_mfma_f32_32x32x16_bf16 v[64:79], v[84:87], v[232:235], v[64:79]
    ds_read_b128 v[248:251], v10 offset:16384
    ds_read_b64_tr_b16 v[80:81], v12 offset:45056
    ds_read_b64_tr_b16 v[82:83], v12 offset:45568
    ds_read_b64_tr_b16 v[84:85], v13 offset:45056
    ds_read_b64_tr_b16 v[86:87], v13 offset:45568
    v_mfma_f32_32x32x16_bf16 v[48:63], v[88:91], v[236:239], v[48:63]
    v_mfma_f32_32x32x16_bf16 v[64:79], v[92:95], v[236:239], v[64:79]
    ds_read_b128 v[252:255], v11 offset:16384
    ds_read_b64_tr_b16 v[88:89], v12 offset:47104
    ds_read_b64_tr_b16 v[90:91], v12 offset:47616
    ds_read_b64_tr_b16 v[92:93], v13 offset:47104
    ds_read_b64_tr_b16 v[94:95], v13 offset:47616
    s_waitcnt lgkmcnt(15)
    v_mfma_f32_32x32x16_bf16 v[48:63], v[24:27], v[240:243], v[48:63]
    v_mfma_f32_32x32x16_bf16 v[64:79], v[28:31], v[240:243], v[64:79]
    s_waitcnt lgkmcnt(10)
    v_mfma_f32_32x32x16_bf16 v[48:63], v[32:35], v[244:247], v[48:63]
    v_mfma_f32_32x32x16_bf16 v[64:79], v[36:39], v[244:247], v[64:79]
    s_waitcnt lgkmcnt(0)
    s_barrier
    ds_read_b64_tr_b16 v[24:25], v14 offset:0
    ds_read_b64_tr_b16 v[26:27], v14 offset:512
    ds_read_b64_tr_b16 v[28:29], v14 offset:2048
    ds_read_b64_tr_b16 v[30:31], v14 offset:2560
    ds_read_b64_tr_b16 v[32:33], v14 offset:4096
    ds_read_b64_tr_b16 v[34:35], v14 offset:4608
    v_mfma_f32_32x32x16_bf16 v[48:63], v[80:83], v[248:251], v[48:63]
    v_mfma_f32_32x32x16_bf16 v[64:79], v[84:87], v[248:251], v[64:79]
    ds_read_b64_tr_b16 v[36:37], v14 offset:6144
    ds_read_b64_tr_b16 v[38:39], v14 offset:6656
    ds_read_b64_tr_b16 v[40:41], v14 offset:8192
    ds_read_b64_tr_b16 v[42:43], v14 offset:8704
    ds_read_b64_tr_b16 v[44:45], v14 offset:10240
    ds_read_b64_tr_b16 v[46:47], v14 offset:10752
    v_mfma_f32_32x32x16_bf16 v[48:63], v[88:91], v[252:255], v[48:63]
    v_mfma_f32_32x32x16_bf16 v[64:79], v[92:95], v[252:255], v[64:79]
    ds_read_b64_tr_b16 v[8:9], v14 offset:12288
    ds_read_b64_tr_b16 v[10:11], v14 offset:12800
    s_waitcnt lgkmcnt(12)
    v_mfma_f32_32x32x16_bf16 v[80:95], v[24:27], v[96:99], 0
    ds_read_b64_tr_b16 v[24:25], v14 offset:14336
    ds_read_b64_tr_b16 v[26:27], v14 offset:14848
    s_waitcnt lgkmcnt(12)
    v_mfma_f32_32x32x16_bf16 v[80:95], v[28:31], v[100:103], v[80:95]
    s_nop 2
    v_mul_f32 v48, s32, v48
    v_mul_f32 v49, s32, v49
    ds_read_b64_tr_b16 v[28:29], v14 offset:16384
    ds_read_b64_tr_b16 v[30:31], v14 offset:16896
    s_waitcnt lgkmcnt(12)
    v_mfma_f32_32x32x16_bf16 v[80:95], v[32:35], v[104:107], v[80:95]
    v_mul_f32 v50, s32, v50
    v_mul_f32 v51, s32, v51
    ds_read_b64_tr_b16 v[32:33], v14 offset:18432
    ds_read_b64_tr_b16 v[34:35], v14 offset:18944
    s_waitcnt lgkmcnt(12)
    v_mfma_f32_32x32x16_bf16 v[80:95], v[36:39], v[108:111], v[80:95]
    v_mul_f32 v52, s32, v52
    v_mul_f32 v53, s32, v53
    ds_read_b64_tr_b16 v[36:37], v14 offset:20480
    ds_read_b64_tr_b16 v[38:39], v14 offset:20992
    s_waitcnt lgkmcnt(12)
    v_mfma_f32_32x32x16_bf16 v[80:95], v[40:43], v[112:115], v[80:95]
    v_mul_f32 v54, s32, v54
    v_mul_f32 v55, s32, v55
    ds_read_b64_tr_b16 v[40:41], v14 offset:22528
    ds_read_b64_tr_b16 v[42:43], v14 offset:23040
    s_waitcnt lgkmcnt(12)
    v_mfma_f32_32x32x16_bf16 v[80:95], v[44:47], v[116:119], v[80:95]
    v_cvt_pk_bf16_f32 v48, v48, v49
    s_barrier
    ds_read_b64_tr_b16 v[44:45], v12 offset:0
    ds_read_b64_tr_b16 v[46:47], v12 offset:512
    s_waitcnt lgkmcnt(12)
    v_mfma_f32_32x32x16_bf16 v[80:95], v[8:11], v[120:123], v[80:95]
    v_cvt_pk_bf16_f32 v49, v50, v51
    v_cvt_pk_bf16_f32 v50, v52, v53
    ds_read_b64_tr_b16 v[8:9], v12 offset:2048
    ds_read_b64_tr_b16 v[10:11], v12 offset:2560
    s_waitcnt lgkmcnt(12)
    v_mfma_f32_32x32x16_bf16 v[80:95], v[24:27], v[124:127], v[80:95]
    v_cvt_pk_bf16_f32 v51, v54, v55
    buffer_store_dwordx4 v[48:51], v16, s[36:39], s33 offen offset:0 sc1
    ds_read_b64_tr_b16 v[24:25], v12 offset:4096
    ds_read_b64_tr_b16 v[26:27], v12 offset:4608
    s_waitcnt lgkmcnt(12)
    v_mfma_f32_32x32x16_bf16 v[80:95], v[28:31], v[128:131], v[80:95]
    v_mul_f32 v56, s32, v56
    v_mul_f32 v57, s32, v57
    ds_read_b64_tr_b16 v[28:29], v12 offset:6144
    ds_read_b64_tr_b16 v[30:31], v12 offset:6656
    s_waitcnt lgkmcnt(12)
    v_mfma_f32_32x32x16_bf16 v[80:95], v[32:35], v[132:135], v[80:95]
    v_mul_f32 v58, s32, v58
    v_mul_f32 v59, s32, v59
    ds_read_b64_tr_b16 v[32:33], v12 offset:8192
    ds_read_b64_tr_b16 v[34:35], v12 offset:8704
    s_waitcnt lgkmcnt(12)
    v_mfma_f32_32x32x16_bf16 v[80:95], v[36:39], v[136:139], v[80:95]
    v_mul_f32 v60, s32, v60
    ds_read_b64_tr_b16 v[36:37], v12 offset:10240
    ds_read_b64_tr_b16 v[38:39], v12 offset:10752
    s_waitcnt lgkmcnt(12)
    v_mfma_f32_32x32x16_bf16 v[80:95], v[40:43], v[140:143], v[80:95]
    v_mul_f32 v61, s32, v61
    v_mul_f32 v62, s32, v62
    ds_read_b64_tr_b16 v[40:41], v12 offset:12288
    ds_read_b64_tr_b16 v[42:43], v12 offset:12800
    s_waitcnt lgkmcnt(12)
    v_mfma_f32_32x32x16_bf16 v[80:95], v[44:47], v[144:147], v[80:95]
    v_mul_f32 v63, s32, v63
    v_cvt_pk_bf16_f32 v56, v56, v57
    ds_read_b64_tr_b16 v[44:45], v12 offset:14336
    ds_read_b64_tr_b16 v[46:47], v12 offset:14848
    s_waitcnt lgkmcnt(12)
    v_mfma_f32_32x32x16_bf16 v[80:95], v[8:11], v[148:151], v[80:95]
    v_cvt_pk_bf16_f32 v57, v58, v59
    v_cvt_pk_bf16_f32 v58, v60, v61
    ds_read_b64_tr_b16 v[8:9], v12 offset:49152
    ds_read_b64_tr_b16 v[10:11], v12 offset:49664
    s_waitcnt lgkmcnt(12)
    v_mfma_f32_32x32x16_bf16 v[80:95], v[24:27], v[152:155], v[80:95]
    v_cvt_pk_bf16_f32 v59, v62, v63
    buffer_store_dwordx4 v[56:59], v16, s[36:39], s33 offen offset:1024 sc1
    ds_read_b64_tr_b16 v[24:25], v12 offset:51200
    ds_read_b64_tr_b16 v[26:27], v12 offset:51712
    s_waitcnt lgkmcnt(12)
    v_mfma_f32_32x32x16_bf16 v[80:95], v[28:31], v[156:159], v[80:95]
    v_mul_f32 v64, s32, v64
    ds_read_b64_tr_b16 v[28:29], v12 offset:53248
    ds_read_b64_tr_b16 v[30:31], v12 offset:53760
    s_waitcnt lgkmcnt(12)
    v_mfma_f32_32x32x16_bf16 v[80:95], v[32:35], v[160:163], v[80:95]
    v_mul_f32 v65, s32, v65
    v_mul_f32 v66, s32, v66
    ds_read_b64_tr_b16 v[32:33], v12 offset:55296
    ds_read_b64_tr_b16 v[34:35], v12 offset:55808
    s_waitcnt lgkmcnt(12)
    v_mfma_f32_32x32x16_bf16 v[80:95], v[36:39], v[164:167], v[80:95]
    v_mul_f32 v67, s32, v67
    v_mul_f32 v68, s32, v68
    s_barrier
    ds_read_b64_tr_b16 v[36:37], v12 offset:16384
    ds_read_b64_tr_b16 v[38:39], v12 offset:16896
    s_waitcnt lgkmcnt(12)
    v_mfma_f32_32x32x16_bf16 v[80:95], v[40:43], v[168:171], v[80:95]
    v_mul_f32 v69, s32, v69
    v_mul_f32 v70, s32, v70
    ds_read_b64_tr_b16 v[40:41], v12 offset:18432
    ds_read_b64_tr_b16 v[42:43], v12 offset:18944
    s_waitcnt lgkmcnt(12)
    v_mfma_f32_32x32x16_bf16 v[80:95], v[44:47], v[172:175], v[80:95]
    v_mul_f32 v71, s32, v71
    v_cvt_pk_bf16_f32 v64, v64, v65
    ds_read_b64_tr_b16 v[44:45], v12 offset:20480
    ds_read_b64_tr_b16 v[46:47], v12 offset:20992
    s_waitcnt lgkmcnt(12)
    v_mfma_f32_32x32x16_bf16 v[80:95], v[8:11], v[176:179], v[80:95]
    v_cvt_pk_bf16_f32 v65, v66, v67
    ds_read_b64_tr_b16 v[8:9], v12 offset:22528
    ds_read_b64_tr_b16 v[10:11], v12 offset:23040
    s_waitcnt lgkmcnt(12)
    v_mfma_f32_32x32x16_bf16 v[80:95], v[24:27], v[180:183], v[80:95]
    v_cvt_pk_bf16_f32 v66, v68, v69
    v_cvt_pk_bf16_f32 v67, v70, v71
    ds_read_b64_tr_b16 v[24:25], v12 offset:24576
    ds_read_b64_tr_b16 v[26:27], v12 offset:25088
    s_waitcnt lgkmcnt(12)
    v_mfma_f32_32x32x16_bf16 v[80:95], v[28:31], v[184:187], v[80:95]
    buffer_store_dwordx4 v[64:67], v16, s[36:39], s33 offen offset:2048 sc1
    v_mul_f32 v72, s32, v72
    ds_read_b64_tr_b16 v[28:29], v12 offset:26624
    ds_read_b64_tr_b16 v[30:31], v12 offset:27136
    s_waitcnt lgkmcnt(12)
    v_mfma_f32_32x32x16_bf16 v[80:95], v[32:35], v[188:191], v[80:95]
    v_mul_f32 v73, s32, v73
    v_mul_f32 v74, s32, v74
    ds_read_b64_tr_b16 v[32:33], v12 offset:28672
    ds_read_b64_tr_b16 v[34:35], v12 offset:29184
    s_waitcnt lgkmcnt(12)
    v_mfma_f32_32x32x16_bf16 v[80:95], v[36:39], v[192:195], v[80:95]
    v_mul_f32 v75, s32, v75
    v_mul_f32 v76, s32, v76
    ds_read_b64_tr_b16 v[36:37], v12 offset:30720
    ds_read_b64_tr_b16 v[38:39], v12 offset:31232
    s_waitcnt lgkmcnt(12)
    v_mfma_f32_32x32x16_bf16 v[80:95], v[40:43], v[196:199], v[80:95]
    v_mul_f32 v77, s32, v77
    ds_read_b64_tr_b16 v[40:41], v12 offset:57344
    ds_read_b64_tr_b16 v[42:43], v12 offset:57856
    s_waitcnt lgkmcnt(12)
    v_mfma_f32_32x32x16_bf16 v[80:95], v[44:47], v[200:203], v[80:95]
    v_mul_f32 v78, s32, v78
    v_mul_f32 v79, s32, v79
    ds_read_b64_tr_b16 v[44:45], v12 offset:59392
    ds_read_b64_tr_b16 v[46:47], v12 offset:59904
    s_waitcnt lgkmcnt(12)
    v_mfma_f32_32x32x16_bf16 v[80:95], v[8:11], v[204:207], v[80:95]
    v_cvt_pk_bf16_f32 v72, v72, v73
    v_cvt_pk_bf16_f32 v73, v74, v75
    ds_read_b64_tr_b16 v[8:9], v12 offset:61440
    ds_read_b64_tr_b16 v[10:11], v12 offset:61952
    s_waitcnt lgkmcnt(12)
    v_mfma_f32_32x32x16_bf16 v[80:95], v[24:27], v[208:211], v[80:95]
    v_cvt_pk_bf16_f32 v74, v76, v77
    v_cvt_pk_bf16_f32 v75, v78, v79
    ds_read_b64_tr_b16 v[24:25], v12 offset:63488
    ds_read_b64_tr_b16 v[26:27], v12 offset:64000
    s_waitcnt lgkmcnt(12)
    v_mfma_f32_32x32x16_bf16 v[80:95], v[28:31], v[212:215], v[80:95]
    buffer_store_dwordx4 v[72:75], v16, s[36:39], s33 offen offset:3072 sc1
    ds_read_b64_tr_b16 v[28:29], v14 offset:24576
    ds_read_b64_tr_b16 v[30:31], v14 offset:25088
    s_waitcnt lgkmcnt(12)
    v_mfma_f32_32x32x16_bf16 v[80:95], v[32:35], v[216:219], v[80:95]
    ds_read_b64_tr_b16 v[32:33], v14 offset:26624
    ds_read_b64_tr_b16 v[34:35], v14 offset:27136
    s_waitcnt lgkmcnt(12)
    v_mfma_f32_32x32x16_bf16 v[80:95], v[36:39], v[220:223], v[80:95]
    ds_read_b64_tr_b16 v[36:37], v14 offset:28672
    ds_read_b64_tr_b16 v[38:39], v14 offset:29184
    s_waitcnt lgkmcnt(12)
    v_mfma_f32_32x32x16_bf16 v[80:95], v[40:43], v[224:227], v[80:95]
    ds_read_b64_tr_b16 v[40:41], v14 offset:30720
    ds_read_b64_tr_b16 v[42:43], v14 offset:31232
    s_waitcnt lgkmcnt(12)
    v_mfma_f32_32x32x16_bf16 v[80:95], v[44:47], v[228:231], v[80:95]
    ds_read_b64_tr_b16 v[44:45], v15 offset:0
    ds_read_b64_tr_b16 v[46:47], v15 offset:512
    s_waitcnt lgkmcnt(12)
    v_mfma_f32_32x32x16_bf16 v[80:95], v[8:11], v[232:235], v[80:95]
    ds_read_b64_tr_b16 v[8:9], v15 offset:2048
    ds_read_b64_tr_b16 v[10:11], v15 offset:2560
    s_waitcnt lgkmcnt(12)
    v_mfma_f32_32x32x16_bf16 v[80:95], v[24:27], v[236:239], v[80:95]
    ds_read_b64_tr_b16 v[24:25], v15 offset:4096
    ds_read_b64_tr_b16 v[26:27], v15 offset:4608
    s_waitcnt lgkmcnt(12)
    v_mfma_f32_32x32x16_bf16 v[80:95], v[28:31], v[240:243], v[80:95]
    ds_read_b64_tr_b16 v[28:29], v15 offset:6144
    ds_read_b64_tr_b16 v[30:31], v15 offset:6656
    s_waitcnt lgkmcnt(12)
    v_mfma_f32_32x32x16_bf16 v[80:95], v[32:35], v[244:247], v[80:95]
    ds_read_b64_tr_b16 v[32:33], v15 offset:8192
    ds_read_b64_tr_b16 v[34:35], v15 offset:8704
    s_waitcnt lgkmcnt(12)
    v_mfma_f32_32x32x16_bf16 v[80:95], v[36:39], v[248:251], v[80:95]
    ds_read_b64_tr_b16 v[36:37], v15 offset:10240
    ds_read_b64_tr_b16 v[38:39], v15 offset:10752
    s_waitcnt lgkmcnt(12)
    v_mfma_f32_32x32x16_bf16 v[80:95], v[40:43], v[252:255], v[80:95]
    ds_read_b64_tr_b16 v[40:41], v15 offset:12288
    ds_read_b64_tr_b16 v[42:43], v15 offset:12800
    s_waitcnt lgkmcnt(12)
    v_mfma_f32_32x32x16_bf16 v[48:63], v[44:47], v[96:99], 0
    ds_read_b64_tr_b16 v[44:45], v15 offset:14336
    ds_read_b64_tr_b16 v[46:47], v15 offset:14848
    s_waitcnt lgkmcnt(12)
    v_mfma_f32_32x32x16_bf16 v[48:63], v[8:11], v[100:103], v[48:63]
    s_nop 3
    v_mul_f32 v80, s32, v80
    v_mul_f32 v81, s32, v81
    ds_read_b64_tr_b16 v[8:9], v15 offset:16384
    ds_read_b64_tr_b16 v[10:11], v15 offset:16896
    s_waitcnt lgkmcnt(12)
    v_mfma_f32_32x32x16_bf16 v[48:63], v[24:27], v[104:107], v[48:63]
    v_mul_f32 v82, s32, v82
    v_mul_f32 v83, s32, v83
    ds_read_b64_tr_b16 v[24:25], v15 offset:18432
    ds_read_b64_tr_b16 v[26:27], v15 offset:18944
    s_waitcnt lgkmcnt(12)
    v_mfma_f32_32x32x16_bf16 v[48:63], v[28:31], v[108:111], v[48:63]
    v_mul_f32 v84, s32, v84
    v_mul_f32 v85, s32, v85
    ds_read_b64_tr_b16 v[28:29], v15 offset:20480
    ds_read_b64_tr_b16 v[30:31], v15 offset:20992
    s_waitcnt lgkmcnt(12)
    v_mfma_f32_32x32x16_bf16 v[48:63], v[32:35], v[112:115], v[48:63]
    v_mul_f32 v86, s32, v86
    ds_read_b64_tr_b16 v[32:33], v15 offset:22528
    ds_read_b64_tr_b16 v[34:35], v15 offset:23040
    s_waitcnt lgkmcnt(12)
    v_mfma_f32_32x32x16_bf16 v[48:63], v[36:39], v[116:119], v[48:63]
    v_mul_f32 v87, s32, v87
    v_cvt_pk_bf16_f32 v80, v80, v81
    ds_read_b64_tr_b16 v[36:37], v13 offset:0
    ds_read_b64_tr_b16 v[38:39], v13 offset:512
    s_waitcnt lgkmcnt(12)
    v_mfma_f32_32x32x16_bf16 v[48:63], v[40:43], v[120:123], v[48:63]
    v_cvt_pk_bf16_f32 v81, v82, v83
    v_cvt_pk_bf16_f32 v82, v84, v85
    ds_read_b64_tr_b16 v[40:41], v13 offset:2048
    ds_read_b64_tr_b16 v[42:43], v13 offset:2560
    s_waitcnt lgkmcnt(12)
    v_mfma_f32_32x32x16_bf16 v[48:63], v[44:47], v[124:127], v[48:63]
    v_cvt_pk_bf16_f32 v83, v86, v87
    buffer_store_dwordx4 v[80:83], v16, s[36:39], s30 offen offset:0 sc1
    ds_read_b64_tr_b16 v[44:45], v13 offset:4096
    ds_read_b64_tr_b16 v[46:47], v13 offset:4608
    s_waitcnt lgkmcnt(12)
    v_mfma_f32_32x32x16_bf16 v[48:63], v[8:11], v[128:131], v[48:63]
    v_mul_f32 v88, s32, v88
    ds_read_b64_tr_b16 v[8:9], v13 offset:6144
    ds_read_b64_tr_b16 v[10:11], v13 offset:6656
    s_waitcnt lgkmcnt(12)
    v_mfma_f32_32x32x16_bf16 v[48:63], v[24:27], v[132:135], v[48:63]
    v_mul_f32 v89, s32, v89
    v_mul_f32 v90, s32, v90
    ds_read_b64_tr_b16 v[24:25], v13 offset:8192
    ds_read_b64_tr_b16 v[26:27], v13 offset:8704
    s_waitcnt lgkmcnt(12)
    v_mfma_f32_32x32x16_bf16 v[48:63], v[28:31], v[136:139], v[48:63]
    v_mul_f32 v91, s32, v91
    v_mul_f32 v92, s32, v92
    ds_read_b64_tr_b16 v[28:29], v13 offset:10240
    ds_read_b64_tr_b16 v[30:31], v13 offset:10752
    s_waitcnt lgkmcnt(12)
    v_mfma_f32_32x32x16_bf16 v[48:63], v[32:35], v[140:143], v[48:63]
    v_mul_f32 v93, s32, v93
    v_mul_f32 v94, s32, v94
    ds_read_b64_tr_b16 v[32:33], v13 offset:12288
    ds_read_b64_tr_b16 v[34:35], v13 offset:12800
    s_waitcnt lgkmcnt(12)
    v_mfma_f32_32x32x16_bf16 v[48:63], v[36:39], v[144:147], v[48:63]
    v_mul_f32 v95, s32, v95
    ds_read_b64_tr_b16 v[36:37], v13 offset:14336
    ds_read_b64_tr_b16 v[38:39], v13 offset:14848
    s_waitcnt lgkmcnt(12)
    v_mfma_f32_32x32x16_bf16 v[48:63], v[40:43], v[148:151], v[48:63]
    v_cvt_pk_bf16_f32 v88, v88, v89
    v_cvt_pk_bf16_f32 v89, v90, v91
    ds_read_b64_tr_b16 v[40:41], v13 offset:49152
    ds_read_b64_tr_b16 v[42:43], v13 offset:49664
    s_waitcnt lgkmcnt(12)
    v_mfma_f32_32x32x16_bf16 v[48:63], v[44:47], v[152:155], v[48:63]
    v_cvt_pk_bf16_f32 v90, v92, v93
    v_cvt_pk_bf16_f32 v91, v94, v95
    ds_read_b64_tr_b16 v[44:45], v13 offset:51200
    ds_read_b64_tr_b16 v[46:47], v13 offset:51712
    s_waitcnt lgkmcnt(12)
    v_mfma_f32_32x32x16_bf16 v[48:63], v[8:11], v[156:159], v[48:63]
    buffer_store_dwordx4 v[88:91], v16, s[36:39], s30 offen offset:1024 sc1
    ds_read_b64_tr_b16 v[8:9], v13 offset:53248
    ds_read_b64_tr_b16 v[10:11], v13 offset:53760
    s_waitcnt lgkmcnt(12)
    v_mfma_f32_32x32x16_bf16 v[48:63], v[24:27], v[160:163], v[48:63]
    ds_read_b64_tr_b16 v[24:25], v13 offset:55296
    ds_read_b64_tr_b16 v[26:27], v13 offset:55808
    s_waitcnt lgkmcnt(12)
    v_mfma_f32_32x32x16_bf16 v[48:63], v[28:31], v[164:167], v[48:63]
    ds_read_b64_tr_b16 v[28:29], v13 offset:16384
    ds_read_b64_tr_b16 v[30:31], v13 offset:16896
    s_waitcnt lgkmcnt(12)
    v_mfma_f32_32x32x16_bf16 v[48:63], v[32:35], v[168:171], v[48:63]
    ds_read_b64_tr_b16 v[32:33], v13 offset:18432
    ds_read_b64_tr_b16 v[34:35], v13 offset:18944
    s_waitcnt lgkmcnt(12)
    v_mfma_f32_32x32x16_bf16 v[48:63], v[36:39], v[172:175], v[48:63]
    ds_read_b64_tr_b16 v[36:37], v13 offset:20480
    ds_read_b64_tr_b16 v[38:39], v13 offset:20992
    s_waitcnt lgkmcnt(12)
    v_mfma_f32_32x32x16_bf16 v[48:63], v[40:43], v[176:179], v[48:63]
    ds_read_b64_tr_b16 v[40:41], v13 offset:22528
    ds_read_b64_tr_b16 v[42:43], v13 offset:23040
    s_waitcnt lgkmcnt(12)
    v_mfma_f32_32x32x16_bf16 v[48:63], v[44:47], v[180:183], v[48:63]
    ds_read_b64_tr_b16 v[44:45], v13 offset:24576
    ds_read_b64_tr_b16 v[46:47], v13 offset:25088
    s_waitcnt lgkmcnt(12)
    v_mfma_f32_32x32x16_bf16 v[48:63], v[8:11], v[184:187], v[48:63]
    ds_read_b64_tr_b16 v[8:9], v13 offset:26624
    ds_read_b64_tr_b16 v[10:11], v13 offset:27136
    s_waitcnt lgkmcnt(12)
    v_mfma_f32_32x32x16_bf16 v[48:63], v[24:27], v[188:191], v[48:63]
    ds_read_b64_tr_b16 v[24:25], v13 offset:28672
    ds_read_b64_tr_b16 v[26:27], v13 offset:29184
    s_waitcnt lgkmcnt(12)
    v_mfma_f32_32x32x16_bf16 v[48:63], v[28:31], v[192:195], v[48:63]
    ds_read_b64_tr_b16 v[28:29], v13 offset:30720
    ds_read_b64_tr_b16 v[30:31], v13 offset:31232
    s_waitcnt lgkmcnt(12)
    v_mfma_f32_32x32x16_bf16 v[48:63], v[32:35], v[196:199], v[48:63]
    ds_read_b64_tr_b16 v[32:33], v13 offset:57344
    ds_read_b64_tr_b16 v[34:35], v13 offset:57856
    s_waitcnt lgkmcnt(12)
    v_mfma_f32_32x32x16_bf16 v[48:63], v[36:39], v[200:203], v[48:63]
    ds_read_b64_tr_b16 v[36:37], v13 offset:59392
    ds_read_b64_tr_b16 v[38:39], v13 offset:59904
    s_waitcnt lgkmcnt(12)
    v_mfma_f32_32x32x16_bf16 v[48:63], v[40:43], v[204:207], v[48:63]
    ds_read_b64_tr_b16 v[40:41], v13 offset:61440
    ds_read_b64_tr_b16 v[42:43], v13 offset:61952
    s_waitcnt lgkmcnt(12)
    v_mfma_f32_32x32x16_bf16 v[48:63], v[44:47], v[208:211], v[48:63]
    ds_read_b64_tr_b16 v[44:45], v13 offset:63488
    ds_read_b64_tr_b16 v[46:47], v13 offset:64000
    s_waitcnt lgkmcnt(12)
    v_mfma_f32_32x32x16_bf16 v[48:63], v[8:11], v[212:215], v[48:63]
    ds_read_b64_tr_b16 v[8:9], v15 offset:24576
    ds_read_b64_tr_b16 v[10:11], v15 offset:25088
    s_waitcnt lgkmcnt(12)
    v_mfma_f32_32x32x16_bf16 v[48:63], v[24:27], v[216:219], v[48:63]
    ds_read_b64_tr_b16 v[24:25], v15 offset:26624
    ds_read_b64_tr_b16 v[26:27], v15 offset:27136
    s_waitcnt lgkmcnt(12)
    v_mfma_f32_32x32x16_bf16 v[48:63], v[28:31], v[220:223], v[48:63]
    ds_read_b64_tr_b16 v[28:29], v15 offset:28672
    ds_read_b64_tr_b16 v[30:31], v15 offset:29184
    s_waitcnt lgkmcnt(12)
    v_mfma_f32_32x32x16_bf16 v[48:63], v[32:35], v[224:227], v[48:63]
    ds_read_b64_tr_b16 v[32:33], v15 offset:30720
    ds_read_b64_tr_b16 v[34:35], v15 offset:31232
    s_waitcnt lgkmcnt(12)
    v_mfma_f32_32x32x16_bf16 v[48:63], v[36:39], v[228:231], v[48:63]
    s_waitcnt lgkmcnt(10)
    v_mfma_f32_32x32x16_bf16 v[48:63], v[40:43], v[232:235], v[48:63]
    s_waitcnt lgkmcnt(8)
    v_mfma_f32_32x32x16_bf16 v[48:63], v[44:47], v[236:239], v[48:63]
    s_waitcnt lgkmcnt(6)
    v_mfma_f32_32x32x16_bf16 v[48:63], v[8:11], v[240:243], v[48:63]
    s_waitcnt lgkmcnt(4)
    v_mfma_f32_32x32x16_bf16 v[48:63], v[24:27], v[244:247], v[48:63]
    s_waitcnt lgkmcnt(2)
    v_mfma_f32_32x32x16_bf16 v[48:63], v[28:31], v[248:251], v[48:63]
    s_waitcnt lgkmcnt(0)
    v_mfma_f32_32x32x16_bf16 v[48:63], v[32:35], v[252:255], v[48:63]
    s_nop 11
    v_mul_f32 v48, s32, v48
    v_mul_f32 v49, s32, v49
    v_mul_f32 v50, s32, v50
    v_mul_f32 v51, s32, v51
    v_mul_f32 v52, s32, v52
    v_mul_f32 v53, s32, v53
    v_mul_f32 v54, s32, v54
    v_mul_f32 v55, s32, v55
    v_cvt_pk_bf16_f32 v48, v48, v49
    v_cvt_pk_bf16_f32 v49, v50, v51
    v_cvt_pk_bf16_f32 v50, v52, v53
    v_cvt_pk_bf16_f32 v51, v54, v55
    buffer_store_dwordx4 v[48:51], v16, s[36:39], s30 offen offset:2048 sc1
    v_mul_f32 v56, s32, v56
    v_mul_f32 v57, s32, v57
    v_mul_f32 v58, s32, v58
    v_mul_f32 v59, s32, v59
    v_mul_f32 v60, s32, v60
    v_mul_f32 v61, s32, v61
    v_mul_f32 v62, s32, v62
    v_mul_f32 v63, s32, v63
    v_cvt_pk_bf16_f32 v56, v56, v57
    v_cvt_pk_bf16_f32 v57, v58, v59
    v_cvt_pk_bf16_f32 v58, v60, v61
    v_cvt_pk_bf16_f32 v59, v62, v63
    buffer_store_dwordx4 v[56:59], v16, s[36:39], s30 offen offset:3072 sc1
    s_branch G_end
G_vsetup:
    s_barrier
    ds_read_b128 v[96:99], v8 offset:0
    ds_read_b64_tr_b16 v[24:25], v12 offset:32768
    ds_read_b64_tr_b16 v[26:27], v12 offset:33280
    ds_read_b64_tr_b16 v[28:29], v13 offset:32768
    ds_read_b64_tr_b16 v[30:31], v13 offset:33280
    ds_read_b128 v[100:103], v9 offset:0
    ds_read_b64_tr_b16 v[32:33], v12 offset:34816
    ds_read_b64_tr_b16 v[34:35], v12 offset:35328
    ds_read_b64_tr_b16 v[36:37], v13 offset:34816
    ds_read_b64_tr_b16 v[38:39], v13 offset:35328
    ds_read_b128 v[104:107], v10 offset:0
    ds_read_b64_tr_b16 v[80:81], v12 offset:36864
    ds_read_b64_tr_b16 v[82:83], v12 offset:37376
    ds_read_b64_tr_b16 v[84:85], v13 offset:36864
    ds_read_b64_tr_b16 v[86:87], v13 offset:37376
    ds_read_b128 v[108:111], v11 offset:0
    ds_read_b64_tr_b16 v[88:89], v12 offset:38912
    ds_read_b64_tr_b16 v[90:91], v12 offset:39424
    ds_read_b64_tr_b16 v[92:93], v13 offset:38912
    ds_read_b64_tr_b16 v[94:95], v13 offset:39424
    s_waitcnt lgkmcnt(15)
    v_mfma_f32_32x32x16_bf16 v[48:63], v[96:99], v[24:27], 0
    v_mfma_f32_32x32x16_bf16 v[64:79], v[96:99], v[28:31], 0
    s_waitcnt lgkmcnt(10)
    v_mfma_f32_32x32x16_bf16 v[48:63], v[100:103], v[32:35], v[48:63]
    v_mfma_f32_32x32x16_bf16 v[64:79], v[100:103], v[36:39], v[64:79]
    s_waitcnt lgkmcnt(0)
    s_mov_b32 s36, s34
    s_mov_b32 s37, s35
    s_mov_b32 s38, 0x2000000
    s_mov_b32 s39, 0x00020000
    s_barrier
    ds_read_b128 v[112:115], v8 offset:16384
    ds_read_b64_tr_b16 v[24:25], v12 offset:40960
    ds_read_b64_tr_b16 v[26:27], v12 offset:41472
    ds_read_b64_tr_b16 v[28:29], v13 offset:40960
    ds_read_b64_tr_b16 v[30:31], v13 offset:41472
    ds_read_b128 v[116:119], v9 offset:16384
    ds_read_b64_tr_b16 v[32:33], v12 offset:43008
    ds_read_b64_tr_b16 v[34:35], v12 offset:43520
    ds_read_b64_tr_b16 v[36:37], v13 offset:43008
    ds_read_b64_tr_b16 v[38:39], v13 offset:43520
    v_mfma_f32_32x32x16_bf16 v[48:63], v[104:107], v[80:83], v[48:63]
    v_mfma_f32_32x32x16_bf16 v[64:79], v[104:107], v[84:87], v[64:79]
    ds_read_b128 v[120:123], v10 offset:16384
    ds_read_b64_tr_b16 v[80:81], v12 offset:45056
    ds_read_b64_tr_b16 v[82:83], v12 offset:45568
    ds_read_b64_tr_b16 v[84:85], v13 offset:45056
    ds_read_b64_tr_b16 v[86:87], v13 offset:45568
    v_mfma_f32_32x32x16_bf16 v[48:63], v[108:111], v[88:91], v[48:63]
    v_mfma_f32_32x32x16_bf16 v[64:79], v[108:111], v[92:95], v[64:79]
    ds_read_b128 v[124:127], v11 offset:16384
    ds_read_b64_tr_b16 v[88:89], v12 offset:47104
    ds_read_b64_tr_b16 v[90:91], v12 offset:47616
    ds_read_b64_tr_b16 v[92:93], v13 offset:47104
    ds_read_b64_tr_b16 v[94:95], v13 offset:47616
    s_waitcnt lgkmcnt(15)
    v_mfma_f32_32x32x16_bf16 v[48:63], v[112:115], v[24:27], v[48:63]
    v_mfma_f32_32x32x16_bf16 v[64:79], v[112:115], v[28:31], v[64:79]
    s_waitcnt lgkmcnt(10)
    v_mfma_f32_32x32x16_bf16 v[48:63], v[116:119], v[32:35], v[48:63]
    v_mfma_f32_32x32x16_bf16 v[64:79], v[116:119], v[36:39], v[64:79]
    s_waitcnt lgkmcnt(0)
    s_cmp_eq_u32 s18, 10
    s_cbranch_scc0 G_no1
    v_lshlrev_b32 v17, 4, v2
    v_mov_b32 v20, 0
    v_mov_b32 v21, 0
    v_mov_b32 v22, 0
    v_mov_b32 v23, 0
    s_mov_b64 exec, 1
    v_mov_b32 v20, 0x3f803f80
    v_mov_b32 v21, 0x3f803f80
    v_mov_b32 v22, 0x3f803f80
    v_mov_b32 v23, 0x3f803f80
    s_mov_b64 exec, 0xff
    buffer_store_dwordx4 v[20:23], v17, s[36:39], s31 offen sc1
    s_mov_b64 exec, -1
G_no1:
    s_barrier
    ds_read_b128 v[128:131], v8 offset:32768
    ds_read_b64_tr_b16 v[24:25], v12 offset:49152
    ds_read_b64_tr_b16 v[26:27], v12 offset:49664
    ds_read_b64_tr_b16 v[28:29], v13 offset:49152
    ds_read_b64_tr_b16 v[30:31], v13 offset:49664
    ds_read_b128 v[132:135], v9 offset:32768
    ds_read_b64_tr_b16 v[32:33], v12 offset:51200
    ds_read_b64_tr_b16 v[34:35], v12 offset:51712
    ds_read_b64_tr_b16 v[36:37], v13 offset:51200
    ds_read_b64_tr_b16 v[38:39], v13 offset:51712
    v_mfma_f32_32x32x16_bf16 v[48:63], v[120:123], v[80:83], v[48:63]
    v_mfma_f32_32x32x16_bf16 v[64:79], v[120:123], v[84:87], v[64:79]
    ds_read_b128 v[136:139], v10 offset:32768
    ds_read_b64_tr_b16 v[80:81], v12 offset:53248
    ds_read_b64_tr_b16 v[82:83], v12 offset:53760
    ds_read_b64_tr_b16 v[84:85], v13 offset:53248
    ds_read_b64_tr_b16 v[86:87], v13 offset:53760
    v_mfma_f32_32x32x16_bf16 v[48:63], v[124:127], v[88:91], v[48:63]
    v_mfma_f32_32x32x16_bf16 v[64:79], v[124:127], v[92:95], v[64:79]
    ds_read_b128 v[140:143], v11 offset:32768
    ds_read_b64_tr_b16 v[88:89], v12 offset:55296
    ds_read_b64_tr_b16 v[90:91], v12 offset:55808
    ds_read_b64_tr_b16 v[92:93], v13 offset:55296
    ds_read_b64_tr_b16 v[94:95], v13 offset:55808
    s_waitcnt lgkmcnt(15)
    v_mfma_f32_32x32x16_bf16 v[48:63], v[128:131], v[24:27], v[48:63]
    v_mfma_f32_32x32x16_bf16 v[64:79], v[128:131], v[28:31], v[64:79]
    s_waitcnt lgkmcnt(10)
    v_mfma_f32_32x32x16_bf16 v[48:63], v[132:135], v[32:35], v[48:63]
    v_mfma_f32_32x32x16_bf16 v[64:79], v[132:135], v[36:39], v[64:79]
    s_waitcnt lgkmcnt(0)
    s_barrier
    ds_read_b128 v[144:147], v8 offset:49152
    ds_read_b64_tr_b16 v[24:25], v12 offset:57344
    ds_read_b64_tr_b16 v[26:27], v12 offset:57856
    ds_read_b64_tr_b16 v[28:29], v13 offset:57344
    ds_read_b64_tr_b16 v[30:31], v13 offset:57856
    ds_read_b128 v[148:151], v9 offset:49152
    ds_read_b64_tr_b16 v[32:33], v12 offset:59392
    ds_read_b64_tr_b16 v[34:35], v12 offset:59904
    ds_read_b64_tr_b16 v[36:37], v13 offset:59392
    ds_read_b64_tr_b16 v[38:39], v13 offset:59904
    v_mfma_f32_32x32x16_bf16 v[48:63], v[136:139], v[80:83], v[48:63]
    v_mfma_f32_32x32x16_bf16 v[64:79], v[136:139], v[84:87], v[64:79]
    ds_read_b128 v[152:155], v10 offset:49152
    ds_read_b64_tr_b16 v[80:81], v12 offset:61440
    ds_read_b64_tr_b16 v[82:83], v12 offset:61952
    ds_read_b64_tr_b16 v[84:85], v13 offset:61440
    ds_read_b64_tr_b16 v[86:87], v13 offset:61952
    v_mfma_f32_32x32x16_bf16 v[48:63], v[140:143], v[88:91], v[48:63]
    v_mfma_f32_32x32x16_bf16 v[64:79], v[140:143], v[92:95], v[64:79]
    ds_read_b128 v[156:159], v11 offset:49152
    ds_read_b64_tr_b16 v[88:89], v12 offset:63488
    ds_read_b64_tr_b16 v[90:91], v12 offset:64000
    ds_read_b64_tr_b16 v[92:93], v13 offset:63488
    ds_read_b64_tr_b16 v[94:95], v13 offset:64000
    s_waitcnt lgkmcnt(15)
    v_mfma_f32_32x32x16_bf16 v[48:63], v[144:147], v[24:27], v[48:63]
    v_mfma_f32_32x32x16_bf16 v[64:79], v[144:147], v[28:31], v[64:79]
    s_waitcnt lgkmcnt(10)
    v_mfma_f32_32x32x16_bf16 v[48:63], v[148:151], v[32:35], v[48:63]
    v_mfma_f32_32x32x16_bf16 v[64:79], v[148:151], v[36:39], v[64:79]
    s_waitcnt lgkmcnt(0)
    s_barrier
    ds_read_b128 v[160:163], v8 offset:0
    ds_read_b64_tr_b16 v[24:25], v12 offset:32768
    ds_read_b64_tr_b16 v[26:27], v12 offset:33280
    ds_read_b64_tr_b16 v[28:29], v13 offset:32768
    ds_read_b64_tr_b16 v[30:31], v13 offset:33280
    ds_read_b128 v[164:167], v9 offset:0
    ds_read_b64_tr_b16 v[32:33], v12 offset:34816
    ds_read_b64_tr_b16 v[34:35], v12 offset:35328
    ds_read_b64_tr_b16 v[36:37], v13 offset:34816
    ds_read_b64_tr_b16 v[38:39], v13 offset:35328
    v_mfma_f32_32x32x16_bf16 v[48:63], v[152:155], v[80:83], v[48:63]
    v_mfma_f32_32x32x16_bf16 v[64:79], v[152:155], v[84:87], v[64:79]
    ds_read_b128 v[168:171], v10 offset:0
    ds_read_b64_tr_b16 v[80:81], v12 offset:36864
    ds_read_b64_tr_b16 v[82:83], v12 offset:37376
    ds_read_b64_tr_b16 v[84:85], v13 offset:36864
    ds_read_b64_tr_b16 v[86:87], v13 offset:37376
    v_mfma_f32_32x32x16_bf16 v[48:63], v[156:159], v[88:91], v[48:63]
    v_mfma_f32_32x32x16_bf16 v[64:79], v[156:159], v[92:95], v[64:79]
    ds_read_b128 v[172:175], v11 offset:0
    ds_read_b64_tr_b16 v[88:89], v12 offset:38912
    ds_read_b64_tr_b16 v[90:91], v12 offset:39424
    ds_read_b64_tr_b16 v[92:93], v13 offset:38912
    ds_read_b64_tr_b16 v[94:95], v13 offset:39424
    s_waitcnt lgkmcnt(15)
    v_mfma_f32_32x32x16_bf16 v[48:63], v[160:163], v[24:27], v[48:63]
    v_mfma_f32_32x32x16_bf16 v[64:79], v[160:163], v[28:31], v[64:79]
    s_waitcnt lgkmcnt(10)
    v_mfma_f32_32x32x16_bf16 v[48:63], v[164:167], v[32:35], v[48:63]
    v_mfma_f32_32x32x16_bf16 v[64:79], v[164:167], v[36:39], v[64:79]
    s_waitcnt lgkmcnt(0)
    s_barrier
    ds_read_b128 v[176:179], v8 offset:16384
    ds_read_b64_tr_b16 v[24:25], v12 offset:40960
    ds_read_b64_tr_b16 v[26:27], v12 offset:41472
    ds_read_b64_tr_b16 v[28:29], v13 offset:40960
    ds_read_b64_tr_b16 v[30:31], v13 offset:41472
    ds_read_b128 v[180:183], v9 offset:16384
    ds_read_b64_tr_b16 v[32:33], v12 offset:43008
    ds_read_b64_tr_b16 v[34:35], v12 offset:43520
    ds_read_b64_tr_b16 v[36:37], v13 offset:43008
    ds_read_b64_tr_b16 v[38:39], v13 offset:43520
    v_mfma_f32_32x32x16_bf16 v[48:63], v[168:171], v[80:83], v[48:63]
    v_mfma_f32_32x32x16_bf16 v[64:79], v[168:171], v[84:87], v[64:79]
    ds_read_b128 v[184:187], v10 offset:16384
    ds_read_b64_tr_b16 v[80:81], v12 offset:45056
    ds_read_b64_tr_b16 v[82:83], v12 offset:45568
    ds_read_b64_tr_b16 v[84:85], v13 offset:45056
    ds_read_b64_tr_b16 v[86:87], v13 offset:45568
    v_mfma_f32_32x32x16_bf16 v[48:63], v[172:175], v[88:91], v[48:63]
    v_mfma_f32_32x32x16_bf16 v[64:79], v[172:175], v[92:95], v[64:79]
    ds_read_b128 v[188:191], v11 offset:16384
    ds_read_b64_tr_b16 v[88:89], v12 offset:47104
    ds_read_b64_tr_b16 v[90:91], v12 offset:47616
    ds_read_b64_tr_b16 v[92:93], v13 offset:47104
    ds_read_b64_tr_b16 v[94:95], v13 offset:47616
    s_waitcnt lgkmcnt(15)
    v_mfma_f32_32x32x16_bf16 v[48:63], v[176:179], v[24:27], v[48:63]
    v_mfma_f32_32x32x16_bf16 v[64:79], v[176:179], v[28:31], v[64:79]
    s_waitcnt lgkmcnt(10)
    v_mfma_f32_32x32x16_bf16 v[48:63], v[180:183], v[32:35], v[48:63]
    v_mfma_f32_32x32x16_bf16 v[64:79], v[180:183], v[36:39], v[64:79]
    s_waitcnt lgkmcnt(0)
    s_barrier
    ds_read_b128 v[192:195], v8 offset:32768
    ds_read_b64_tr_b16 v[24:25], v12 offset:49152
    ds_read_b64_tr_b16 v[26:27], v12 offset:49664
    ds_read_b64_tr_b16 v[28:29], v13 offset:49152
    ds_read_b64_tr_b16 v[30:31], v13 offset:49664
    ds_read_b128 v[196:199], v9 offset:32768
    ds_read_b64_tr_b16 v[32:33], v12 offset:51200
    ds_read_b64_tr_b16 v[34:35], v12 offset:51712
    ds_read_b64_tr_b16 v[36:37], v13 offset:51200
    ds_read_b64_tr_b16 v[38:39], v13 offset:51712
    v_mfma_f32_32x32x16_bf16 v[48:63], v[184:187], v[80:83], v[48:63]
    v_mfma_f32_32x32x16_bf16 v[64:79], v[184:187], v[84:87], v[64:79]
    ds_read_b128 v[200:203], v10 offset:32768
    ds_read_b64_tr_b16 v[80:81], v12 offset:53248
    ds_read_b64_tr_b16 v[82:83], v12 offset:53760
    ds_read_b64_tr_b16 v[84:85], v13 offset:53248
    ds_read_b64_tr_b16 v[86:87], v13 offset:53760
    v_mfma_f32_32x32x16_bf16 v[48:63], v[188:191], v[88:91], v[48:63]
    v_mfma_f32_32x32x16_bf16 v[64:79], v[188:191], v[92:95], v[64:79]
    ds_read_b128 v[204:207], v11 offset:32768
    ds_read_b64_tr_b16 v[88:89], v12 offset:55296
    ds_read_b64_tr_b16 v[90:91], v12 offset:55808
    ds_read_b64_tr_b16 v[92:93], v13 offset:55296
    ds_read_b64_tr_b16 v[94:95], v13 offset:55808
    s_waitcnt lgkmcnt(15)
    v_mfma_f32_32x32x16_bf16 v[48:63], v[192:195], v[24:27], v[48:63]
    v_mfma_f32_32x32x16_bf16 v[64:79], v[192:195], v[28:31], v[64:79]
    s_waitcnt lgkmcnt(10)
    v_mfma_f32_32x32x16_bf16 v[48:63], v[196:199], v[32:35], v[48:63]
    v_mfma_f32_32x32x16_bf16 v[64:79], v[196:199], v[36:39], v[64:79]
    s_waitcnt lgkmcnt(0)
    s_barrier
    ds_read_b128 v[208:211], v8 offset:49152
    ds_read_b64_tr_b16 v[24:25], v12 offset:57344
    ds_read_b64_tr_b16 v[26:27], v12 offset:57856
    ds_read_b64_tr_b16 v[28:29], v13 offset:57344
    ds_read_b64_tr_b16 v[30:31], v13 offset:57856
    ds_read_b128 v[212:215], v9 offset:49152
    ds_read_b64_tr_b16 v[32:33], v12 offset:59392
    ds_read_b64_tr_b16 v[34:35], v12 offset:59904
    ds_read_b64_tr_b16 v[36:37], v13 offset:59392
    ds_read_b64_tr_b16 v[38:39], v13 offset:59904
    v_mfma_f32_32x32x16_bf16 v[48:63], v[200:203], v[80:83], v[48:63]
    v_mfma_f32_32x32x16_bf16 v[64:79], v[200:203], v[84:87], v[64:79]
    ds_read_b128 v[216:219], v10 offset:49152
    ds_read_b64_tr_b16 v[80:81], v12 offset:61440
    ds_read_b64_tr_b16 v[82:83], v12 offset:61952
    ds_read_b64_tr_b16 v[84:85], v13 offset:61440
    ds_read_b64_tr_b16 v[86:87], v13 offset:61952
    v_mfma_f32_32x32x16_bf16 v[48:63], v[204:207], v[88:91], v[48:63]
    v_mfma_f32_32x32x16_bf16 v[64:79], v[204:207], v[92:95], v[64:79]
    ds_read_b128 v[220:223], v11 offset:49152
    ds_read_b64_tr_b16 v[88:89], v12 offset:63488
    ds_read_b64_tr_b16 v[90:91], v12 offset:64000
    ds_read_b64_tr_b16 v[92:93], v13 offset:63488
    ds_read_b64_tr_b16 v[94:95], v13 offset:64000
    s_waitcnt lgkmcnt(15)
    v_mfma_f32_32x32x16_bf16 v[48:63], v[208:211], v[24:27], v[48:63]
    v_mfma_f32_32x32x16_bf16 v[64:79], v[208:211], v[28:31], v[64:79]
    s_waitcnt lgkmcnt(10)
    v_mfma_f32_32x32x16_bf16 v[48:63], v[212:215], v[32:35], v[48:63]
    v_mfma_f32_32x32x16_bf16 v[64:79], v[212:215], v[36:39], v[64:79]
    s_waitcnt lgkmcnt(0)
    s_barrier
    ds_read_b128 v[224:227], v8 offset:0
    ds_read_b64_tr_b16 v[24:25], v12 offset:32768
    ds_read_b64_tr_b16 v[26:27], v12 offset:33280
    ds_read_b64_tr_b16 v[28:29], v13 offset:32768
    ds_read_b64_tr_b16 v[30:31], v13 offset:33280
    ds_read_b128 v[228:231], v9 offset:0
    ds_read_b64_tr_b16 v[32:33], v12 offset:34816
    ds_read_b64_tr_b16 v[34:35], v12 offset:35328
    ds_read_b64_tr_b16 v[36:37], v13 offset:34816
    ds_read_b64_tr_b16 v[38:39], v13 offset:35328
    v_mfma_f32_32x32x16_bf16 v[48:63], v[216:219], v[80:83], v[48:63]
    v_mfma_f32_32x32x16_bf16 v[64:79], v[216:219], v[84:87], v[64:79]
    ds_read_b128 v[232:235], v10 offset:0
    ds_read_b64_tr_b16 v[80:81], v12 offset:36864
    ds_read_b64_tr_b16 v[82:83], v12 offset:37376
    ds_read_b64_tr_b16 v[84:85], v13 offset:36864
    ds_read_b64_tr_b16 v[86:87], v13 offset:37376
    v_mfma_f32_32x32x16_bf16 v[48:63], v[220:223], v[88:91], v[48:63]
    v_mfma_f32_32x32x16_bf16 v[64:79], v[220:223], v[92:95], v[64:79]
    ds_read_b128 v[236:239], v11 offset:0
    ds_read_b64_tr_b16 v[88:89], v12 offset:38912
    ds_read_b64_tr_b16 v[90:91], v12 offset:39424
    ds_read_b64_tr_b16 v[92:93], v13 offset:38912
    ds_read_b64_tr_b16 v[94:95], v13 offset:39424
    s_waitcnt lgkmcnt(15)
    v_mfma_f32_32x32x16_bf16 v[48:63], v[224:227], v[24:27], v[48:63]
    v_mfma_f32_32x32x16_bf16 v[64:79], v[224:227], v[28:31], v[64:79]
    s_waitcnt lgkmcnt(10)
    v_mfma_f32_32x32x16_bf16 v[48:63], v[228:231], v[32:35], v[48:63]
    v_mfma_f32_32x32x16_bf16 v[64:79], v[228:231], v[36:39], v[64:79]
    s_waitcnt lgkmcnt(0)
    s_barrier
    ds_read_b128 v[240:243], v8 offset:16384
    ds_read_b64_tr_b16 v[24:25], v12 offset:40960
    ds_read_b64_tr_b16 v[26:27], v12 offset:41472
    ds_read_b64_tr_b16 v[28:29], v13 offset:40960
    ds_read_b64_tr_b16 v[30:31], v13 offset:41472
    ds_read_b128 v[244:247], v9 offset:16384
    ds_read_b64_tr_b16 v[32:33], v12 offset:43008
    ds_read_b64_tr_b16 v[34:35], v12 offset:43520
    ds_read_b64_tr_b16 v[36:37], v13 offset:43008
    ds_read_b64_tr_b16 v[38:39], v13 offset:43520
    v_mfma_f32_32x32x16_bf16 v[48:63], v[232:235], v[80:83], v[48:63]
    v_mfma_f32_32x32x16_bf16 v[64:79], v[232:235], v[84:87], v[64:79]
    ds_read_b128 v[248:251], v10 offset:16384
    ds_read_b64_tr_b16 v[80:81], v12 offset:45056
    ds_read_b64_tr_b16 v[82:83], v12 offset:45568
    ds_read_b64_tr_b16 v[84:85], v13 offset:45056
    ds_read_b64_tr_b16 v[86:87], v13 offset:45568
    v_mfma_f32_32x32x16_bf16 v[48:63], v[236:239], v[88:91], v[48:63]
    v_mfma_f32_32x32x16_bf16 v[64:79], v[236:239], v[92:95], v[64:79]
    ds_read_b128 v[252:255], v11 offset:16384
    ds_read_b64_tr_b16 v[88:89], v12 offset:47104
    ds_read_b64_tr_b16 v[90:91], v12 offset:47616
    ds_read_b64_tr_b16 v[92:93], v13 offset:47104
    ds_read_b64_tr_b16 v[94:95], v13 offset:47616
    s_waitcnt lgkmcnt(15)
    v_mfma_f32_32x32x16_bf16 v[48:63], v[240:243], v[24:27], v[48:63]
    v_mfma_f32_32x32x16_bf16 v[64:79], v[240:243], v[28:31], v[64:79]
    s_waitcnt lgkmcnt(10)
    v_mfma_f32_32x32x16_bf16 v[48:63], v[244:247], v[32:35], v[48:63]
    v_mfma_f32_32x32x16_bf16 v[64:79], v[244:247], v[36:39], v[64:79]
    s_waitcnt lgkmcnt(0)
    s_barrier
    ds_read_b64_tr_b16 v[24:25], v14 offset:0
    ds_read_b64_tr_b16 v[26:27], v14 offset:512
    ds_read_b64_tr_b16 v[28:29], v14 offset:2048
    ds_read_b64_tr_b16 v[30:31], v14 offset:2560
    ds_read_b64_tr_b16 v[32:33], v14 offset:4096
    ds_read_b64_tr_b16 v[34:35], v14 offset:4608
    v_mfma_f32_32x32x16_bf16 v[48:63], v[248:251], v[80:83], v[48:63]
    v_mfma_f32_32x32x16_bf16 v[64:79], v[248:251], v[84:87], v[64:79]
    ds_read_b64_tr_b16 v[36:37], v14 offset:6144
    ds_read_b64_tr_b16 v[38:39], v14 offset:6656
    ds_read_b64_tr_b16 v[40:41], v14 offset:8192
    ds_read_b64_tr_b16 v[42:43], v14 offset:8704
    ds_read_b64_tr_b16 v[44:45], v14 offset:10240
    ds_read_b64_tr_b16 v[46:47], v14 offset:10752
    v_mfma_f32_32x32x16_bf16 v[48:63], v[252:255], v[88:91], v[48:63]
    v_mfma_f32_32x32x16_bf16 v[64:79], v[252:255], v[92:95], v[64:79]
    ds_read_b64_tr_b16 v[8:9], v14 offset:12288
    ds_read_b64_tr_b16 v[10:11], v14 offset:12800
    s_waitcnt lgkmcnt(12)
    v_mfma_f32_32x32x16_bf16 v[80:95], v[96:99], v[24:27], 0
    ds_read_b64_tr_b16 v[24:25], v14 offset:14336
    ds_read_b64_tr_b16 v[26:27], v14 offset:14848
    s_waitcnt lgkmcnt(12)
    v_mfma_f32_32x32x16_bf16 v[80:95], v[100:103], v[28:31], v[80:95]
    s_nop 2
    v_cvt_pk_bf16_f32 v48, v48, v49
    ds_read_b64_tr_b16 v[28:29], v14 offset:16384
    ds_read_b64_tr_b16 v[30:31], v14 offset:16896
    s_waitcnt lgkmcnt(12)
    v_mfma_f32_32x32x16_bf16 v[80:95], v[104:107], v[32:35], v[80:95]
    v_cvt_pk_bf16_f32 v49, v50, v51
    ds_read_b64_tr_b16 v[32:33], v14 offset:18432
    ds_read_b64_tr_b16 v[34:35], v14 offset:18944
    s_waitcnt lgkmcnt(12)
    v_mfma_f32_32x32x16_bf16 v[80:95], v[108:111], v[36:39], v[80:95]
    v_cvt_pk_bf16_f32 v50, v52, v53
    ds_read_b64_tr_b16 v[36:37], v14 offset:20480
    ds_read_b64_tr_b16 v[38:39], v14 offset:20992
    s_waitcnt lgkmcnt(12)
    v_mfma_f32_32x32x16_bf16 v[80:95], v[112:115], v[40:43], v[80:95]
    ds_read_b64_tr_b16 v[40:41], v14 offset:22528
    ds_read_b64_tr_b16 v[42:43], v14 offset:23040
    s_waitcnt lgkmcnt(12)
    v_mfma_f32_32x32x16_bf16 v[80:95], v[116:119], v[44:47], v[80:95]
    v_cvt_pk_bf16_f32 v51, v54, v55
    s_barrier
    ds_read_b64_tr_b16 v[44:45], v12 offset:0
    ds_read_b64_tr_b16 v[46:47], v12 offset:512
    s_waitcnt lgkmcnt(12)
    v_mfma_f32_32x32x16_bf16 v[80:95], v[120:123], v[8:11], v[80:95]
    buffer_store_dwordx4 v[48:51], v16, s[36:39], s33 offen offset:0 sc1
    ds_read_b64_tr_b16 v[8:9], v12 offset:2048
    ds_read_b64_tr_b16 v[10:11], v12 offset:2560
    s_waitcnt lgkmcnt(12)
    v_mfma_f32_32x32x16_bf16 v[80:95], v[124:127], v[24:27], v[80:95]
    ds_read_b64_tr_b16 v[24:25], v12 offset:4096
    ds_read_b64_tr_b16 v[26:27], v12 offset:4608
    s_waitcnt lgkmcnt(12)
    v_mfma_f32_32x32x16_bf16 v[80:95], v[128:131], v[28:31], v[80:95]
    v_cvt_pk_bf16_f32 v56, v56, v57
    ds_read_b64_tr_b16 v[28:29], v12 offset:6144
    ds_read_b64_tr_b16 v[30:31], v12 offset:6656
    s_waitcnt lgkmcnt(12)
    v_mfma_f32_32x32x16_bf16 v[80:95], v[132:135], v[32:35], v[80:95]
    v_cvt_pk_bf16_f32 v57, v58, v59
    ds_read_b64_tr_b16 v[32:33], v12 offset:8192
    ds_read_b64_tr_b16 v[34:35], v12 offset:8704
    s_waitcnt lgkmcnt(12)
    v_mfma_f32_32x32x16_bf16 v[80:95], v[136:139], v[36:39], v[80:95]
    ds_read_b64_tr_b16 v[36:37], v12 offset:10240
    ds_read_b64_tr_b16 v[38:39], v12 offset:10752
    s_waitcnt lgkmcnt(12)
    v_mfma_f32_32x32x16_bf16 v[80:95], v[140:143], v[40:43], v[80:95]
    v_cvt_pk_bf16_f32 v58, v60, v61
    ds_read_b64_tr_b16 v[40:41], v12 offset:12288
    ds_read_b64_tr_b16 v[42:43], v12 offset:12800
    s_waitcnt lgkmcnt(12)
    v_mfma_f32_32x32x16_bf16 v[80:95], v[144:147], v[44:47], v[80:95]
    v_cvt_pk_bf16_f32 v59, v62, v63
    ds_read_b64_tr_b16 v[44:45], v12 offset:14336
    ds_read_b64_tr_b16 v[46:47], v12 offset:14848
    s_waitcnt lgkmcnt(12)
    v_mfma_f32_32x32x16_bf16 v[80:95], v[148:151], v[8:11], v[80:95]
    ds_read_b64_tr_b16 v[8:9], v12 offset:49152
    ds_read_b64_tr_b16 v[10:11], v12 offset:49664
    s_waitcnt lgkmcnt(12)
    v_mfma_f32_32x32x16_bf16 v[80:95], v[152:155], v[24:27], v[80:95]
    buffer_store_dwordx4 v[56:59], v16, s[36:39], s33 offen offset:1024 sc1
    ds_read_b64_tr_b16 v[24:25], v12 offset:51200
    ds_read_b64_tr_b16 v[26:27], v12 offset:51712
    s_waitcnt lgkmcnt(12)
    v_mfma_f32_32x32x16_bf16 v[80:95], v[156:159], v[28:31], v[80:95]
    v_cvt_pk_bf16_f32 v64, v64, v65
    ds_read_b64_tr_b16 v[28:29], v12 offset:53248
    ds_read_b64_tr_b16 v[30:31], v12 offset:53760
    s_waitcnt lgkmcnt(12)
    v_mfma_f32_32x32x16_bf16 v[80:95], v[160:163], v[32:35], v[80:95]
    v_cvt_pk_bf16_f32 v65, v66, v67
    ds_read_b64_tr_b16 v[32:33], v12 offset:55296
    ds_read_b64_tr_b16 v[34:35], v12 offset:55808
    s_waitcnt lgkmcnt(12)
    v_mfma_f32_32x32x16_bf16 v[80:95], v[164:167], v[36:39], v[80:95]
    s_barrier
    ds_read_b64_tr_b16 v[36:37], v12 offset:16384
    ds_read_b64_tr_b16 v[38:39], v12 offset:16896
    s_waitcnt lgkmcnt(12)
    v_mfma_f32_32x32x16_bf16 v[80:95], v[168:171], v[40:43], v[80:95]
    v_cvt_pk_bf16_f32 v66, v68, v69
    ds_read_b64_tr_b16 v[40:41], v12 offset:18432
    ds_read_b64_tr_b16 v[42:43], v12 offset:18944
    s_waitcnt lgkmcnt(12)
    v_mfma_f32_32x32x16_bf16 v[80:95], v[172:175], v[44:47], v[80:95]
    v_cvt_pk_bf16_f32 v67, v70, v71
    ds_read_b64_tr_b16 v[44:45], v12 offset:20480
    ds_read_b64_tr_b16 v[46:47], v12 offset:20992
    s_waitcnt lgkmcnt(12)
    v_mfma_f32_32x32x16_bf16 v[80:95], v[176:179], v[8:11], v[80:95]
    ds_read_b64_tr_b16 v[8:9], v12 offset:22528
    ds_read_b64_tr_b16 v[10:11], v12 offset:23040
    s_waitcnt lgkmcnt(12)
    v_mfma_f32_32x32x16_bf16 v[80:95], v[180:183], v[24:27], v[80:95]
    buffer_store_dwordx4 v[64:67], v16, s[36:39], s33 offen offset:2048 sc1
    ds_read_b64_tr_b16 v[24:25], v12 offset:24576
    ds_read_b64_tr_b16 v[26:27], v12 offset:25088
    s_waitcnt lgkmcnt(12)
    v_mfma_f32_32x32x16_bf16 v[80:95], v[184:187], v[28:31], v[80:95]
    v_cvt_pk_bf16_f32 v72, v72, v73
    ds_read_b64_tr_b16 v[28:29], v12 offset:26624
    ds_read_b64_tr_b16 v[30:31], v12 offset:27136
    s_waitcnt lgkmcnt(12)
    v_mfma_f32_32x32x16_bf16 v[80:95], v[188:191], v[32:35], v[80:95]
    ds_read_b64_tr_b16 v[32:33], v12 offset:28672
    ds_read_b64_tr_b16 v[34:35], v12 offset:29184
    s_waitcnt lgkmcnt(12)
    v_mfma_f32_32x32x16_bf16 v[80:95], v[192:195], v[36:39], v[80:95]
    v_cvt_pk_bf16_f32 v73, v74, v75
    ds_read_b64_tr_b16 v[36:37], v12 offset:30720
    ds_read_b64_tr_b16 v[38:39], v12 offset:31232
    s_waitcnt lgkmcnt(12)
    v_mfma_f32_32x32x16_bf16 v[80:95], v[196:199], v[40:43], v[80:95]
    v_cvt_pk_bf16_f32 v74, v76, v77
    ds_read_b64_tr_b16 v[40:41], v12 offset:57344
    ds_read_b64_tr_b16 v[42:43], v12 offset:57856
    s_waitcnt lgkmcnt(12)
    v_mfma_f32_32x32x16_bf16 v[80:95], v[200:203], v[44:47], v[80:95]
    ds_read_b64_tr_b16 v[44:45], v12 offset:59392
    ds_read_b64_tr_b16 v[46:47], v12 offset:59904
    s_waitcnt lgkmcnt(12)
    v_mfma_f32_32x32x16_bf16 v[80:95], v[204:207], v[8:11], v[80:95]
    v_cvt_pk_bf16_f32 v75, v78, v79
    ds_read_b64_tr_b16 v[8:9], v12 offset:61440
    ds_read_b64_tr_b16 v[10:11], v12 offset:61952
    s_waitcnt lgkmcnt(12)
    v_mfma_f32_32x32x16_bf16 v[80:95], v[208:211], v[24:27], v[80:95]
    buffer_store_dwordx4 v[72:75], v16, s[36:39], s33 offen offset:3072 sc1
    ds_read_b64_tr_b16 v[24:25], v12 offset:63488
    ds_read_b64_tr_b16 v[26:27], v12 offset:64000
    s_waitcnt lgkmcnt(12)
    v_mfma_f32_32x32x16_bf16 v[80:95], v[212:215], v[28:31], v[80:95]
    ds_read_b64_tr_b16 v[28:29], v14 offset:24576
    ds_read_b64_tr_b16 v[30:31], v14 offset:25088
    s_waitcnt lgkmcnt(12)
    v_mfma_f32_32x32x16_bf16 v[80:95], v[216:219], v[32:35], v[80:95]
    ds_read_b64_tr_b16 v[32:33], v14 offset:26624
    ds_read_b64_tr_b16 v[34:35], v14 offset:27136
    s_waitcnt lgkmcnt(12)
    v_mfma_f32_32x32x16_bf16 v[80:95], v[220:223], v[36:39], v[80:95]
    ds_read_b64_tr_b16 v[36:37], v14 offset:28672
    ds_read_b64_tr_b16 v[38:39], v14 offset:29184
    s_waitcnt lgkmcnt(12)
    v_mfma_f32_32x32x16_bf16 v[80:95], v[224:227], v[40:43], v[80:95]
    ds_read_b64_tr_b16 v[40:41], v14 offset:30720
    ds_read_b64_tr_b16 v[42:43], v14 offset:31232
    s_waitcnt lgkmcnt(12)
    v_mfma_f32_32x32x16_bf16 v[80:95], v[228:231], v[44:47], v[80:95]
    ds_read_b64_tr_b16 v[44:45], v15 offset:0
    ds_read_b64_tr_b16 v[46:47], v15 offset:512
    s_waitcnt lgkmcnt(12)
    v_mfma_f32_32x32x16_bf16 v[80:95], v[232:235], v[8:11], v[80:95]
    ds_read_b64_tr_b16 v[8:9], v15 offset:2048
    ds_read_b64_tr_b16 v[10:11], v15 offset:2560
    s_waitcnt lgkmcnt(12)
    v_mfma_f32_32x32x16_bf16 v[80:95], v[236:239], v[24:27], v[80:95]
    ds_read_b64_tr_b16 v[24:25], v15 offset:4096
    ds_read_b64_tr_b16 v[26:27], v15 offset:4608
    s_waitcnt lgkmcnt(12)
    v_mfma_f32_32x32x16_bf16 v[80:95], v[240:243], v[28:31], v[80:95]
    ds_read_b64_tr_b16 v[28:29], v15 offset:6144
    ds_read_b64_tr_b16 v[30:31], v15 offset:6656
    s_waitcnt lgkmcnt(12)
    v_mfma_f32_32x32x16_bf16 v[80:95], v[244:247], v[32:35], v[80:95]
    ds_read_b64_tr_b16 v[32:33], v15 offset:8192
    ds_read_b64_tr_b16 v[34:35], v15 offset:8704
    s_waitcnt lgkmcnt(12)
    v_mfma_f32_32x32x16_bf16 v[80:95], v[248:251], v[36:39], v[80:95]
    ds_read_b64_tr_b16 v[36:37], v15 offset:10240
    ds_read_b64_tr_b16 v[38:39], v15 offset:10752
    s_waitcnt lgkmcnt(12)
    v_mfma_f32_32x32x16_bf16 v[80:95], v[252:255], v[40:43], v[80:95]
    ds_read_b64_tr_b16 v[40:41], v15 offset:12288
    ds_read_b64_tr_b16 v[42:43], v15 offset:12800
    s_waitcnt lgkmcnt(12)
    v_mfma_f32_32x32x16_bf16 v[48:63], v[96:99], v[44:47], 0
    ds_read_b64_tr_b16 v[44:45], v15 offset:14336
    ds_read_b64_tr_b16 v[46:47], v15 offset:14848
    s_waitcnt lgkmcnt(12)
    v_mfma_f32_32x32x16_bf16 v[48:63], v[100:103], v[8:11], v[48:63]
    s_nop 3
    v_cvt_pk_bf16_f32 v80, v80, v81
    ds_read_b64_tr_b16 v[8:9], v15 offset:16384
    ds_read_b64_tr_b16 v[10:11], v15 offset:16896
    s_waitcnt lgkmcnt(12)
    v_mfma_f32_32x32x16_bf16 v[48:63], v[104:107], v[24:27], v[48:63]
    v_cvt_pk_bf16_f32 v81, v82, v83
    ds_read_b64_tr_b16 v[24:25], v15 offset:18432
    ds_read_b64_tr_b16 v[26:27], v15 offset:18944
    s_waitcnt lgkmcnt(12)
    v_mfma_f32_32x32x16_bf16 v[48:63], v[108:111], v[28:31], v[48:63]
    ds_read_b64_tr_b16 v[28:29], v15 offset:20480
    ds_read_b64_tr_b16 v[30:31], v15 offset:20992
    s_waitcnt lgkmcnt(12)
    v_mfma_f32_32x32x16_bf16 v[48:63], v[112:115], v[32:35], v[48:63]
    v_cvt_pk_bf16_f32 v82, v84, v85
    ds_read_b64_tr_b16 v[32:33], v15 offset:22528
    ds_read_b64_tr_b16 v[34:35], v15 offset:23040
    s_waitcnt lgkmcnt(12)
    v_mfma_f32_32x32x16_bf16 v[48:63], v[116:119], v[36:39], v[48:63]
    v_cvt_pk_bf16_f32 v83, v86, v87
    ds_read_b64_tr_b16 v[36:37], v13 offset:0
    ds_read_b64_tr_b16 v[38:39], v13 offset:512
    s_waitcnt lgkmcnt(12)
    v_mfma_f32_32x32x16_bf16 v[48:63], v[120:123], v[40:43], v[48:63]
    ds_read_b64_tr_b16 v[40:41], v13 offset:2048
    ds_read_b64_tr_b16 v[42:43], v13 offset:2560
    s_waitcnt lgkmcnt(12)
    v_mfma_f32_32x32x16_bf16 v[48:63], v[124:127], v[44:47], v[48:63]
    buffer_store_dwordx4 v[80:83], v16, s[36:39], s30 offen offset:0 sc1
    ds_read_b64_tr_b16 v[44:45], v13 offset:4096
    ds_read_b64_tr_b16 v[46:47], v13 offset:4608
    s_waitcnt lgkmcnt(12)
    v_mfma_f32_32x32x16_bf16 v[48:63], v[128:131], v[8:11], v[48:63]
    v_cvt_pk_bf16_f32 v88, v88, v89
    ds_read_b64_tr_b16 v[8:9], v13 offset:6144
    ds_read_b64_tr_b16 v[10:11], v13 offset:6656
    s_waitcnt lgkmcnt(12)
    v_mfma_f32_32x32x16_bf16 v[48:63], v[132:135], v[24:27], v[48:63]
    ds_read_b64_tr_b16 v[24:25], v13 offset:8192
    ds_read_b64_tr_b16 v[26:27], v13 offset:8704
    s_waitcnt lgkmcnt(12)
    v_mfma_f32_32x32x16_bf16 v[48:63], v[136:139], v[28:31], v[48:63]
    v_cvt_pk_bf16_f32 v89, v90, v91
    ds_read_b64_tr_b16 v[28:29], v13 offset:10240
    ds_read_b64_tr_b16 v[30:31], v13 offset:10752
    s_waitcnt lgkmcnt(12)
    v_mfma_f32_32x32x16_bf16 v[48:63], v[140:143], v[32:35], v[48:63]
    v_cvt_pk_bf16_f32 v90, v92, v93
    ds_read_b64_tr_b16 v[32:33], v13 offset:12288
    ds_read_b64_tr_b16 v[34:35], v13 offset:12800
    s_waitcnt lgkmcnt(12)
    v_mfma_f32_32x32x16_bf16 v[48:63], v[144:147], v[36:39], v[48:63]
    ds_read_b64_tr_b16 v[36:37], v13 offset:14336
    ds_read_b64_tr_b16 v[38:39], v13 offset:14848
    s_waitcnt lgkmcnt(12)
    v_mfma_f32_32x32x16_bf16 v[48:63], v[148:151], v[40:43], v[48:63]
    v_cvt_pk_bf16_f32 v91, v94, v95
    ds_read_b64_tr_b16 v[40:41], v13 offset:49152
    ds_read_b64_tr_b16 v[42:43], v13 offset:49664
    s_waitcnt lgkmcnt(12)
    v_mfma_f32_32x32x16_bf16 v[48:63], v[152:155], v[44:47], v[48:63]
    buffer_store_dwordx4 v[88:91], v16, s[36:39], s30 offen offset:1024 sc1
    ds_read_b64_tr_b16 v[44:45], v13 offset:51200
    ds_read_b64_tr_b16 v[46:47], v13 offset:51712
    s_waitcnt lgkmcnt(12)
    v_mfma_f32_32x32x16_bf16 v[48:63], v[156:159], v[8:11], v[48:63]
    ds_read_b64_tr_b16 v[8:9], v13 offset:53248
    ds_read_b64_tr_b16 v[10:11], v13 offset:53760
    s_waitcnt lgkmcnt(12)
    v_mfma_f32_32x32x16_bf16 v[48:63], v[160:163], v[24:27], v[48:63]
    ds_read_b64_tr_b16 v[24:25], v13 offset:55296
    ds_read_b64_tr_b16 v[26:27], v13 offset:55808
    s_waitcnt lgkmcnt(12)
    v_mfma_f32_32x32x16_bf16 v[48:63], v[164:167], v[28:31], v[48:63]
    ds_read_b64_tr_b16 v[28:29], v13 offset:16384
    ds_read_b64_tr_b16 v[30:31], v13 offset:16896
    s_waitcnt lgkmcnt(12)
    v_mfma_f32_32x32x16_bf16 v[48:63], v[168:171], v[32:35], v[48:63]
    ds_read_b64_tr_b16 v[32:33], v13 offset:18432
    ds_read_b64_tr_b16 v[34:35], v13 offset:18944
    s_waitcnt lgkmcnt(12)
    v_mfma_f32_32x32x16_bf16 v[48:63], v[172:175], v[36:39], v[48:63]
    ds_read_b64_tr_b16 v[36:37], v13 offset:20480
    ds_read_b64_tr_b16 v[38:39], v13 offset:20992
    s_waitcnt lgkmcnt(12)
    v_mfma_f32_32x32x16_bf16 v[48:63], v[176:179], v[40:43], v[48:63]
    ds_read_b64_tr_b16 v[40:41], v13 offset:22528
    ds_read_b64_tr_b16 v[42:43], v13 offset:23040
    s_waitcnt lgkmcnt(12)
    v_mfma_f32_32x32x16_bf16 v[48:63], v[180:183], v[44:47], v[48:63]
    ds_read_b64_tr_b16 v[44:45], v13 offset:24576
    ds_read_b64_tr_b16 v[46:47], v13 offset:25088
    s_waitcnt lgkmcnt(12)
    v_mfma_f32_32x32x16_bf16 v[48:63], v[184:187], v[8:11], v[48:63]
    ds_read_b64_tr_b16 v[8:9], v13 offset:26624
    ds_read_b64_tr_b16 v[10:11], v13 offset:27136
    s_waitcnt lgkmcnt(12)
    v_mfma_f32_32x32x16_bf16 v[48:63], v[188:191], v[24:27], v[48:63]
    ds_read_b64_tr_b16 v[24:25], v13 offset:28672
    ds_read_b64_tr_b16 v[26:27], v13 offset:29184
    s_waitcnt lgkmcnt(12)
    v_mfma_f32_32x32x16_bf16 v[48:63], v[192:195], v[28:31], v[48:63]
    ds_read_b64_tr_b16 v[28:29], v13 offset:30720
    ds_read_b64_tr_b16 v[30:31], v13 offset:31232
    s_waitcnt lgkmcnt(12)
    v_mfma_f32_32x32x16_bf16 v[48:63], v[196:199], v[32:35], v[48:63]
    ds_read_b64_tr_b16 v[32:33], v13 offset:57344
    ds_read_b64_tr_b16 v[34:35], v13 offset:57856
    s_waitcnt lgkmcnt(12)
    v_mfma_f32_32x32x16_bf16 v[48:63], v[200:203], v[36:39], v[48:63]
    ds_read_b64_tr_b16 v[36:37], v13 offset:59392
    ds_read_b64_tr_b16 v[38:39], v13 offset:59904
    s_waitcnt lgkmcnt(12)
    v_mfma_f32_32x32x16_bf16 v[48:63], v[204:207], v[40:43], v[48:63]
    ds_read_b64_tr_b16 v[40:41], v13 offset:61440
    ds_read_b64_tr_b16 v[42:43], v13 offset:61952
    s_waitcnt lgkmcnt(12)
    v_mfma_f32_32x32x16_bf16 v[48:63], v[208:211], v[44:47], v[48:63]
    ds_read_b64_tr_b16 v[44:45], v13 offset:63488
    ds_read_b64_tr_b16 v[46:47], v13 offset:64000
    s_waitcnt lgkmcnt(12)
    v_mfma_f32_32x32x16_bf16 v[48:63], v[212:215], v[8:11], v[48:63]
    ds_read_b64_tr_b16 v[8:9], v15 offset:24576
    ds_read_b64_tr_b16 v[10:11], v15 offset:25088
    s_waitcnt lgkmcnt(12)
    v_mfma_f32_32x32x16_bf16 v[48:63], v[216:219], v[24:27], v[48:63]
    ds_read_b64_tr_b16 v[24:25], v15 offset:26624
    ds_read_b64_tr_b16 v[26:27], v15 offset:27136
    s_waitcnt lgkmcnt(12)
    v_mfma_f32_32x32x16_bf16 v[48:63], v[220:223], v[28:31], v[48:63]
    ds_read_b64_tr_b16 v[28:29], v15 offset:28672
    ds_read_b64_tr_b16 v[30:31], v15 offset:29184
    s_waitcnt lgkmcnt(12)
    v_mfma_f32_32x32x16_bf16 v[48:63], v[224:227], v[32:35], v[48:63]
    ds_read_b64_tr_b16 v[32:33], v15 offset:30720
    ds_read_b64_tr_b16 v[34:35], v15 offset:31232
    s_waitcnt lgkmcnt(12)
    v_mfma_f32_32x32x16_bf16 v[48:63], v[228:231], v[36:39], v[48:63]
    s_waitcnt lgkmcnt(10)
    v_mfma_f32_32x32x16_bf16 v[48:63], v[232:235], v[40:43], v[48:63]
    s_waitcnt lgkmcnt(8)
    v_mfma_f32_32x32x16_bf16 v[48:63], v[236:239], v[44:47], v[48:63]
    s_waitcnt lgkmcnt(6)
    v_mfma_f32_32x32x16_bf16 v[48:63], v[240:243], v[8:11], v[48:63]
    s_waitcnt lgkmcnt(4)
    v_mfma_f32_32x32x16_bf16 v[48:63], v[244:247], v[24:27], v[48:63]
    s_waitcnt lgkmcnt(2)
    v_mfma_f32_32x32x16_bf16 v[48:63], v[248:251], v[28:31], v[48:63]
    s_waitcnt lgkmcnt(0)
    v_mfma_f32_32x32x16_bf16 v[48:63], v[252:255], v[32:35], v[48:63]
    s_nop 11
    v_cvt_pk_bf16_f32 v48, v48, v49
    v_cvt_pk_bf16_f32 v49, v50, v51
    v_cvt_pk_bf16_f32 v50, v52, v53
    v_cvt_pk_bf16_f32 v51, v54, v55
    buffer_store_dwordx4 v[48:51], v16, s[36:39], s30 offen offset:2048 sc1
    v_cvt_pk_bf16_f32 v56, v56, v57
    v_cvt_pk_bf16_f32 v57, v58, v59
    v_cvt_pk_bf16_f32 v58, v60, v61
    v_cvt_pk_bf16_f32 v59, v62, v63
    buffer_store_dwordx4 v[56:59], v16, s[36:39], s30 offen offset:3072 sc1
G_end:
G_exit:
    s_endpgm
L_entry:
    s_setprio 3
    s_load_dwordx2 s[40:41], s[0:1], 24
    s_and_b32 s21, s17, 3
    s_lshl_b32 s21, s21, 1
    s_and_b32 s24, s18, 7
    s_add_u32 s21, s21, s24
    s_mul_i32 s21, s21, 5
    s_lshr_b32 s21, s21, 2
    s_cmp_ge_u32 s21, 10
    s_cselect_b32 s24, 10, 0
    s_sub_u32 s21, s21, s24
    s_and_b32 s21, s17, 3
    s_and_b32 s24, s18, 7
    s_add_u32 s21, s21, s24
    s_lshl_b32 s21, s21, 2
    s_mov_b32 s44, 2519766576
    s_mov_b32 s45, 1584
    s_lshr_b64 s[44:45], s[44:45], s21
    s_and_b32 s21, s44, 15
    s_mul_i32 s19, s17, 163840
    s_lshl_b32 s20, s18, 8
    s_xor_b32 s46, s20, 128
    v_lshrrev_b32 v16, 3, v2
    v_mul_u32_u24 v17, 1280, v16
    v_and_b32 v18, 7, v2
    v_lshrrev_b32 v19, 1, v16
    v_xor_b32 v20, v18, v19
    v_lshl_add_u32 v8, v20, 4, v17
    v_xor_b32 v20, 4, v20
    v_lshl_add_u32 v9, v20, 4, v17
    v_add_u32 v9, 9216, v9
    v_add_u32 v10, 18432, v8
    v_add_u32 v11, 18432, v9
    v_mul_u32_u24 v17, 3840, v16
    v_and_b32 v19, 1, v19
    v_lshlrev_b32 v19, 2, v19
    v_xor_b32 v20, v18, v19
    v_lshl_add_u32 v12, v20, 4, v17
    v_add_u32 v13, 29696, v12
    v_add_u32 v14, 59392, v12
    v_add_u32 v15, 89088, v12
    s_cmp_eq_u32 s16, 1
    s_waitcnt lgkmcnt(0)
    s_mov_b32 s8, s4
    s_mov_b32 s9, s5
    s_mov_b32 s10, 0x280000
    s_mov_b32 s11, 0x00020000
    s_mov_b32 s12, s6
    s_mov_b32 s13, s7
    s_mov_b32 s14, 0x258000
    s_mov_b32 s15, 0x00020000
    s_cbranch_scc1 L_1
    s_lshl_b32 s22, s21, 7
    s_add_u32 s22, s22, s19
    s_mov_b32 m0, 65536
    s_add_u32 s24, s22, 0
    buffer_load_dwordx4 v8, s[8:11], s24 offen offset:0 lds
    buffer_load_dwordx4 v9, s[8:11], s24 offen offset:1024 lds
    buffer_load_dwordx4 v10, s[8:11], s24 offen offset:2048 lds
    buffer_load_dwordx4 v11, s[8:11], s24 offen offset:3072 lds
    s_mov_b32 m0, 69632
    s_add_u32 s24, s22, 40960
    buffer_load_dwordx4 v8, s[8:11], s24 offen offset:0 lds
    buffer_load_dwordx4 v9, s[8:11], s24 offen offset:1024 lds
    buffer_load_dwordx4 v10, s[8:11], s24 offen offset:2048 lds
    buffer_load_dwordx4 v11, s[8:11], s24 offen offset:3072 lds
    s_mov_b32 m0, 73728
    s_add_u32 s24, s22, 81920
    buffer_load_dwordx4 v8, s[8:11], s24 offen offset:0 lds
    buffer_load_dwordx4 v9, s[8:11], s24 offen offset:1024 lds
    buffer_load_dwordx4 v10, s[8:11], s24 offen offset:2048 lds
    buffer_load_dwordx4 v11, s[8:11], s24 offen offset:3072 lds
    s_add_u32 s21, s21, 1
    s_cmp_eq_u32 s21, 10
    s_cselect_b32 s21, 0, s21
    s_lshl_b32 s22, s21, 7
    s_add_u32 s22, s22, s19
    s_mov_b32 m0, 81920
    s_add_u32 s24, s22, 0
    buffer_load_dwordx4 v8, s[8:11], s24 offen offset:0 lds
    buffer_load_dwordx4 v9, s[8:11], s24 offen offset:1024 lds
    buffer_load_dwordx4 v10, s[8:11], s24 offen offset:2048 lds
    buffer_load_dwordx4 v11, s[8:11], s24 offen offset:3072 lds
    s_mov_b32 m0, 86016
    s_add_u32 s24, s22, 40960
    buffer_load_dwordx4 v8, s[8:11], s24 offen offset:0 lds
    buffer_load_dwordx4 v9, s[8:11], s24 offen offset:1024 lds
    buffer_load_dwordx4 v10, s[8:11], s24 offen offset:2048 lds
    buffer_load_dwordx4 v11, s[8:11], s24 offen offset:3072 lds
    s_mov_b32 m0, 90112
    s_add_u32 s24, s22, 81920
    buffer_load_dwordx4 v8, s[8:11], s24 offen offset:0 lds
    buffer_load_dwordx4 v9, s[8:11], s24 offen offset:1024 lds
    buffer_load_dwordx4 v10, s[8:11], s24 offen offset:2048 lds
    buffer_load_dwordx4 v11, s[8:11], s24 offen offset:3072 lds
    s_add_u32 s21, s21, 1
    s_cmp_eq_u32 s21, 10
    s_cselect_b32 s21, 0, s21
    s_lshl_b32 s22, s21, 7
    s_add_u32 s22, s22, s19
    s_mov_b32 m0, 98304
    s_add_u32 s24, s22, 0
    buffer_load_dwordx4 v8, s[8:11], s24 offen offset:0 lds
    buffer_load_dwordx4 v9, s[8:11], s24 offen offset:1024 lds
    buffer_load_dwordx4 v10, s[8:11], s24 offen offset:2048 lds
    buffer_load_dwordx4 v11, s[8:11], s24 offen offset:3072 lds
    s_mov_b32 m0, 102400
    s_add_u32 s24, s22, 40960
    buffer_load_dwordx4 v8, s[8:11], s24 offen offset:0 lds
    buffer_load_dwordx4 v9, s[8:11], s24 offen offset:1024 lds
    buffer_load_dwordx4 v10, s[8:11], s24 offen offset:2048 lds
    buffer_load_dwordx4 v11, s[8:11], s24 offen offset:3072 lds
    s_mov_b32 m0, 106496
    s_add_u32 s24, s22, 81920
    buffer_load_dwordx4 v8, s[8:11], s24 offen offset:0 lds
    buffer_load_dwordx4 v9, s[8:11], s24 offen offset:1024 lds
    buffer_load_dwordx4 v10, s[8:11], s24 offen offset:2048 lds
    buffer_load_dwordx4 v11, s[8:11], s24 offen offset:3072 lds
    s_add_u32 s21, s21, 1
    s_cmp_eq_u32 s21, 10
    s_cselect_b32 s21, 0, s21
    s_waitcnt vmcnt(24)
    s_barrier
    s_lshl_b32 s22, s21, 7
    s_add_u32 s22, s22, s19
    s_mov_b32 m0, 114688
    s_add_u32 s24, s22, 0
    buffer_load_dwordx4 v8, s[8:11], s24 offen offset:0 lds
    buffer_load_dwordx4 v9, s[8:11], s24 offen offset:1024 lds
    buffer_load_dwordx4 v10, s[8:11], s24 offen offset:2048 lds
    buffer_load_dwordx4 v11, s[8:11], s24 offen offset:3072 lds
    s_mov_b32 m0, 118784
    s_add_u32 s24, s22, 40960
    buffer_load_dwordx4 v8, s[8:11], s24 offen offset:0 lds
    buffer_load_dwordx4 v9, s[8:11], s24 offen offset:1024 lds
    buffer_load_dwordx4 v10, s[8:11], s24 offen offset:2048 lds
    buffer_load_dwordx4 v11, s[8:11], s24 offen offset:3072 lds
    s_mov_b32 m0, 122880
    s_add_u32 s24, s22, 81920
    buffer_load_dwordx4 v8, s[8:11], s24 offen offset:0 lds
    buffer_load_dwordx4 v9, s[8:11], s24 offen offset:1024 lds
    buffer_load_dwordx4 v10, s[8:11], s24 offen offset:2048 lds
    buffer_load_dwordx4 v11, s[8:11], s24 offen offset:3072 lds
    s_add_u32 s21, s21, 1
    s_cmp_eq_u32 s21, 10
    s_cselect_b32 s21, 0, s21
    s_lshl_b32 s26, s18, 4
    s_add_u32 s26, s26, s17
    s_add_u32 s26, s26, 0
    s_and_b32 s28, s26, 31
    s_lshr_b32 s29, s26, 5
    s_mul_i32 s26, s28, 81920
    s_lshl_b32 s30, s29, 7
    s_add_u32 s26, s26, s30
    s_lshl_b32 s27, s29, 18
    s_lshl_b32 s28, s28, 7
    s_sub_u32 s27, s27, s28
    s_add_u32 s27, s27, 20975488
    s_cmp_ge_u32 s18, 16
    s_cselect_b32 s42, 0, 2621440
    s_mov_b32 s43, 0x00020000
    v_lshrrev_b32 v18, 3, v2
    v_and_b32 v19, 7, v2
    v_mul_u32_u24 v24, 1280, v18
    v_lshl_add_u32 v24, v19, 4, v24
    v_lshlrev_b32 v28, 12, v18
    v_lshl_add_u32 v28, v19, 4, v28
    v_xor_b32 v20, v18, v19
    v_lshlrev_b32 v20, 4, v20
    v_lshl_add_u32 v27, v18, 7, v20
    v_add_u32 v27, 73728, v27
    v_lshlrev_b32 v19, 4, v19
    v_lshl_add_u32 v26, v2, 7, v19
    v_add_u32 v26, 73728, v26
    v_bfe_u32 v18, v2, 2, 2
    v_sub_u32 v18, 3, v18
    v_lshlrev_b32 v18, 7, v18
    v_lshrrev_b32 v19, 4, v2
    v_lshl_add_u32 v18, v19, 5, v18
    v_and_b32 v19, 3, v2
    v_lshl_add_u32 v18, v19, 3, v18
    v_add_u32 v25, 73728, v18
    s_mov_b32 s36, s34
    s_mov_b32 s37, s35
    s_mov_b32 s38, 0x2000000
    s_mov_b32 s39, 0x00020000
    s_waitcnt vmcnt(24)
    s_barrier
    s_lshl_b32 s22, s21, 7
    s_add_u32 s22, s22, s19
    s_mov_b32 m0, 65536
    s_add_u32 s24, s22, 0
    buffer_load_dwordx4 v8, s[8:11], s24 offen offset:0 lds
    buffer_load_dwordx4 v9, s[8:11], s24 offen offset:1024 lds
    buffer_load_dwordx4 v10, s[8:11], s24 offen offset:2048 lds
    buffer_load_dwordx4 v11, s[8:11], s24 offen offset:3072 lds
    s_mov_b32 m0, 69632
    s_add_u32 s24, s22, 40960
    buffer_load_dwordx4 v8, s[8:11], s24 offen offset:0 lds
    buffer_load_dwordx4 v9, s[8:11], s24 offen offset:1024 lds
    buffer_load_dwordx4 v10, s[8:11], s24 offen offset:2048 lds
    buffer_load_dwordx4 v11, s[8:11], s24 offen offset:3072 lds
    s_mov_b32 m0, 73728
    s_add_u32 s24, s22, 81920
    buffer_load_dwordx4 v8, s[8:11], s24 offen offset:0 lds
    buffer_load_dwordx4 v9, s[8:11], s24 offen offset:1024 lds
    buffer_load_dwordx4 v10, s[8:11], s24 offen offset:2048 lds
    buffer_load_dwordx4 v11, s[8:11], s24 offen offset:3072 lds
    s_add_u32 s21, s21, 1
    s_cmp_eq_u32 s21, 10
    s_cselect_b32 s21, 0, s21
    s_waitcnt vmcnt(24)
    s_barrier
    s_lshl_b32 s22, s21, 7
    s_add_u32 s22, s22, s19
    s_mov_b32 m0, 81920
    s_add_u32 s24, s22, 0
    buffer_load_dwordx4 v8, s[8:11], s24 offen offset:0 lds
    buffer_load_dwordx4 v9, s[8:11], s24 offen offset:1024 lds
    buffer_load_dwordx4 v10, s[8:11], s24 offen offset:2048 lds
    buffer_load_dwordx4 v11, s[8:11], s24 offen offset:3072 lds
    s_mov_b32 m0, 86016
    s_add_u32 s24, s22, 40960
    buffer_load_dwordx4 v8, s[8:11], s24 offen offset:0 lds
    buffer_load_dwordx4 v9, s[8:11], s24 offen offset:1024 lds
    buffer_load_dwordx4 v10, s[8:11], s24 offen offset:2048 lds
    buffer_load_dwordx4 v11, s[8:11], s24 offen offset:3072 lds
    s_mov_b32 m0, 90112
    s_add_u32 s24, s22, 81920
    buffer_load_dwordx4 v8, s[8:11], s24 offen offset:0 lds
    buffer_load_dwordx4 v9, s[8:11], s24 offen offset:1024 lds
    buffer_load_dwordx4 v10, s[8:11], s24 offen offset:2048 lds
    buffer_load_dwordx4 v11, s[8:11], s24 offen offset:3072 lds
    s_add_u32 s21, s21, 1
    s_cmp_eq_u32 s21, 10
    s_cselect_b32 s21, 0, s21
    s_waitcnt vmcnt(24)
    s_barrier
    s_lshl_b32 s22, s21, 7
    s_add_u32 s22, s22, s19
    s_mov_b32 m0, 98304
    s_add_u32 s24, s22, 0
    buffer_load_dwordx4 v8, s[8:11], s24 offen offset:0 lds
    buffer_load_dwordx4 v9, s[8:11], s24 offen offset:1024 lds
    buffer_load_dwordx4 v10, s[8:11], s24 offen offset:2048 lds
    buffer_load_dwordx4 v11, s[8:11], s24 offen offset:3072 lds
    s_mov_b32 m0, 102400
    s_add_u32 s24, s22, 40960
    buffer_load_dwordx4 v8, s[8:11], s24 offen offset:0 lds
    buffer_load_dwordx4 v9, s[8:11], s24 offen offset:1024 lds
    buffer_load_dwordx4 v10, s[8:11], s24 offen offset:2048 lds
    buffer_load_dwordx4 v11, s[8:11], s24 offen offset:3072 lds
    s_mov_b32 m0, 106496
    s_add_u32 s24, s22, 81920
    buffer_load_dwordx4 v8, s[8:11], s24 offen offset:0 lds
    buffer_load_dwordx4 v9, s[8:11], s24 offen offset:1024 lds
    buffer_load_dwordx4 v10, s[8:11], s24 offen offset:2048 lds
    buffer_load_dwordx4 v11, s[8:11], s24 offen offset:3072 lds
    s_add_u32 s21, s21, 1
    s_cmp_eq_u32 s21, 10
    s_cselect_b32 s21, 0, s21
    s_waitcnt vmcnt(24)
    s_barrier
    s_lshl_b32 s22, s21, 7
    s_add_u32 s22, s22, s19
    s_mov_b32 m0, 114688
    s_add_u32 s24, s22, 0
    buffer_load_dwordx4 v8, s[8:11], s24 offen offset:0 lds
    buffer_load_dwordx4 v9, s[8:11], s24 offen offset:1024 lds
    buffer_load_dwordx4 v10, s[8:11], s24 offen offset:2048 lds
    buffer_load_dwordx4 v11, s[8:11], s24 offen offset:3072 lds
    s_mov_b32 m0, 118784
    s_add_u32 s24, s22, 40960
    buffer_load_dwordx4 v8, s[8:11], s24 offen offset:0 lds
    buffer_load_dwordx4 v9, s[8:11], s24 offen offset:1024 lds
    buffer_load_dwordx4 v10, s[8:11], s24 offen offset:2048 lds
    buffer_load_dwordx4 v11, s[8:11], s24 offen offset:3072 lds
    s_mov_b32 m0, 122880
    s_add_u32 s24, s22, 81920
    buffer_load_dwordx4 v8, s[8:11], s24 offen offset:0 lds
    buffer_load_dwordx4 v9, s[8:11], s24 offen offset:1024 lds
    buffer_load_dwordx4 v10, s[8:11], s24 offen offset:2048 lds
    buffer_load_dwordx4 v11, s[8:11], s24 offen offset:3072 lds
    s_add_u32 s21, s21, 1
    s_cmp_eq_u32 s21, 10
    s_cselect_b32 s21, 0, s21
    s_waitcnt vmcnt(24)
    s_barrier
    s_lshl_b32 s22, s21, 7
    s_add_u32 s22, s22, s19
    s_mov_b32 m0, 65536
    s_add_u32 s24, s22, 0
    buffer_load_dwordx4 v8, s[8:11], s24 offen offset:0 lds
    buffer_load_dwordx4 v9, s[8:11], s24 offen offset:1024 lds
    buffer_load_dwordx4 v10, s[8:11], s24 offen offset:2048 lds
    buffer_load_dwordx4 v11, s[8:11], s24 offen offset:3072 lds
    s_mov_b32 m0, 69632
    s_add_u32 s24, s22, 40960
    buffer_load_dwordx4 v8, s[8:11], s24 offen offset:0 lds
    buffer_load_dwordx4 v9, s[8:11], s24 offen offset:1024 lds
    buffer_load_dwordx4 v10, s[8:11], s24 offen offset:2048 lds
    buffer_load_dwordx4 v11, s[8:11], s24 offen offset:3072 lds
    s_mov_b32 m0, 73728
    s_add_u32 s24, s22, 81920
    buffer_load_dwordx4 v8, s[8:11], s24 offen offset:0 lds
    buffer_load_dwordx4 v9, s[8:11], s24 offen offset:1024 lds
    buffer_load_dwordx4 v10, s[8:11], s24 offen offset:2048 lds
    buffer_load_dwordx4 v11, s[8:11], s24 offen offset:3072 lds
    s_add_u32 s21, s21, 1
    s_cmp_eq_u32 s21, 10
    s_cselect_b32 s21, 0, s21
    s_waitcnt vmcnt(24)
    s_barrier
    s_lshl_b32 s22, s21, 7
    s_add_u32 s22, s22, s19
    s_mov_b32 m0, 81920
    s_add_u32 s24, s22, 0
    buffer_load_dwordx4 v8, s[8:11], s24 offen offset:0 lds
    buffer_load_dwordx4 v9, s[8:11], s24 offen offset:1024 lds
    buffer_load_dwordx4 v10, s[8:11], s24 offen offset:2048 lds
    buffer_load_dwordx4 v11, s[8:11], s24 offen offset:3072 lds
    s_mov_b32 m0, 86016
    s_add_u32 s24, s22, 40960
    buffer_load_dwordx4 v8, s[8:11], s24 offen offset:0 lds
    buffer_load_dwordx4 v9, s[8:11], s24 offen offset:1024 lds
    buffer_load_dwordx4 v10, s[8:11], s24 offen offset:2048 lds
    buffer_load_dwordx4 v11, s[8:11], s24 offen offset:3072 lds
    s_mov_b32 m0, 90112
    s_add_u32 s24, s22, 81920
    buffer_load_dwordx4 v8, s[8:11], s24 offen offset:0 lds
    buffer_load_dwordx4 v9, s[8:11], s24 offen offset:1024 lds
    buffer_load_dwordx4 v10, s[8:11], s24 offen offset:2048 lds
    buffer_load_dwordx4 v11, s[8:11], s24 offen offset:3072 lds
    s_add_u32 s21, s21, 1
    s_cmp_eq_u32 s21, 10
    s_cselect_b32 s21, 0, s21
    s_mul_i32 s23, s21, 245760
    s_add_u32 s23, s23, s46
    s_mov_b32 m0, 40960
    s_add_u32 s24, s23, 0
    buffer_load_dwordx4 v12, s[12:15], s24 offen offset:0 lds
    buffer_load_dwordx4 v13, s[12:15], s24 offen offset:1024 lds
    buffer_load_dwordx4 v14, s[12:15], s24 offen offset:2048 lds
    buffer_load_dwordx4 v15, s[12:15], s24 offen offset:3072 lds
    s_add_u32 s21, s21, 1
    s_cmp_eq_u32 s21, 10
    s_cselect_b32 s21, 0, s21
    s_mul_i32 s23, s21, 245760
    s_add_u32 s23, s23, s46
    s_mov_b32 m0, 49152
    s_add_u32 s24, s23, 0
    buffer_load_dwordx4 v12, s[12:15], s24 offen offset:0 lds
    buffer_load_dwordx4 v13, s[12:15], s24 offen offset:1024 lds
    buffer_load_dwordx4 v14, s[12:15], s24 offen offset:2048 lds
    buffer_load_dwordx4 v15, s[12:15], s24 offen offset:3072 lds
    s_add_u32 s21, s21, 1
    s_cmp_eq_u32 s21, 10
    s_cselect_b32 s21, 0, s21
    s_mul_i32 s23, s21, 245760
    s_add_u32 s23, s23, s46
    s_mov_b32 m0, 57344
    s_add_u32 s24, s23, 0
    buffer_load_dwordx4 v12, s[12:15], s24 offen offset:0 lds
    buffer_load_dwordx4 v13, s[12:15], s24 offen offset:1024 lds
    buffer_load_dwordx4 v14, s[12:15], s24 offen offset:2048 lds
    buffer_load_dwordx4 v15, s[12:15], s24 offen offset:3072 lds
    s_add_u32 s21, s21, 1
    s_cmp_eq_u32 s21, 10
    s_cselect_b32 s21, 0, s21
    s_waitcnt vmcnt(36)
    s_barrier
    s_mul_i32 s23, s21, 245760
    s_add_u32 s23, s23, s46
    s_mov_b32 m0, 98304
    s_add_u32 s24, s23, 0
    buffer_load_dwordx4 v12, s[12:15], s24 offen offset:0 lds
    buffer_load_dwordx4 v13, s[12:15], s24 offen offset:1024 lds
    buffer_load_dwordx4 v14, s[12:15], s24 offen offset:2048 lds
    buffer_load_dwordx4 v15, s[12:15], s24 offen offset:3072 lds
    s_add_u32 s21, s21, 1
    s_cmp_eq_u32 s21, 10
    s_cselect_b32 s21, 0, s21
    s_mul_i32 s23, s21, 245760
    s_add_u32 s23, s23, s46
    s_mov_b32 m0, 106496
    s_add_u32 s24, s23, 0
    buffer_load_dwordx4 v12, s[12:15], s24 offen offset:0 lds
    buffer_load_dwordx4 v13, s[12:15], s24 offen offset:1024 lds
    buffer_load_dwordx4 v14, s[12:15], s24 offen offset:2048 lds
    buffer_load_dwordx4 v15, s[12:15], s24 offen offset:3072 lds
    s_add_u32 s21, s21, 1
    s_cmp_eq_u32 s21, 10
    s_cselect_b32 s21, 0, s21
    s_mul_i32 s23, s21, 245760
    s_add_u32 s23, s23, s46
    s_mov_b32 m0, 147456
    s_add_u32 s24, s23, 0
    buffer_load_dwordx4 v12, s[12:15], s24 offen offset:0 lds
    buffer_load_dwordx4 v13, s[12:15], s24 offen offset:1024 lds
    buffer_load_dwordx4 v14, s[12:15], s24 offen offset:2048 lds
    buffer_load_dwordx4 v15, s[12:15], s24 offen offset:3072 lds
    s_add_u32 s21, s21, 1
    s_cmp_eq_u32 s21, 10
    s_cselect_b32 s21, 0, s21
    s_waitcnt vmcnt(36)
    s_barrier
    s_mul_i32 s23, s21, 245760
    s_add_u32 s23, s23, s46
    s_mov_b32 m0, 114688
    s_add_u32 s24, s23, 0
    buffer_load_dwordx4 v12, s[12:15], s24 offen offset:0 lds
    buffer_load_dwordx4 v13, s[12:15], s24 offen offset:1024 lds
    buffer_load_dwordx4 v14, s[12:15], s24 offen offset:2048 lds
    buffer_load_dwordx4 v15, s[12:15], s24 offen offset:3072 lds
    s_add_u32 s21, s21, 1
    s_cmp_eq_u32 s21, 10
    s_cselect_b32 s21, 0, s21
    s_mul_i32 s23, s21, 245760
    s_add_u32 s23, s23, s46
    s_mov_b32 m0, 122880
    s_add_u32 s24, s23, 0
    buffer_load_dwordx4 v12, s[12:15], s24 offen offset:0 lds
    buffer_load_dwordx4 v13, s[12:15], s24 offen offset:1024 lds
    buffer_load_dwordx4 v14, s[12:15], s24 offen offset:2048 lds
    buffer_load_dwordx4 v15, s[12:15], s24 offen offset:3072 lds
    s_add_u32 s21, s21, 1
    s_cmp_eq_u32 s21, 10
    s_cselect_b32 s21, 0, s21
    s_mul_i32 s23, s21, 245760
    s_add_u32 s23, s23, s46
    s_mov_b32 m0, 155648
    s_add_u32 s24, s23, 0
    buffer_load_dwordx4 v12, s[12:15], s24 offen offset:0 lds
    buffer_load_dwordx4 v13, s[12:15], s24 offen offset:1024 lds
    buffer_load_dwordx4 v14, s[12:15], s24 offen offset:2048 lds
    buffer_load_dwordx4 v15, s[12:15], s24 offen offset:3072 lds
    s_add_u32 s21, s21, 1
    s_cmp_eq_u32 s21, 10
    s_cselect_b32 s21, 0, s21
    s_waitcnt vmcnt(36)
    s_barrier
    s_mul_i32 s23, s21, 245760
    s_add_u32 s23, s23, s46
    s_mov_b32 m0, 65536
    s_add_u32 s24, s23, 0
    buffer_load_dwordx4 v12, s[12:15], s24 offen offset:0 lds
    buffer_load_dwordx4 v13, s[12:15], s24 offen offset:1024 lds
    buffer_load_dwordx4 v14, s[12:15], s24 offen offset:2048 lds
    buffer_load_dwordx4 v15, s[12:15], s24 offen offset:3072 lds
    s_add_u32 s21, s21, 1
    s_cmp_eq_u32 s21, 10
    s_cselect_b32 s21, 0, s21
    s_waitcnt vmcnt(28)
    s_barrier
    s_waitcnt vmcnt(16)
    s_barrier
    s_waitcnt vmcnt(0)
    s_barrier
    s_endpgm
L_1:
    s_lshl_b32 s22, s21, 7
    s_add_u32 s22, s22, s19
    s_mul_i32 s23, s21, 245760
    s_add_u32 s23, s23, s20
    s_mov_b32 m0, 131072
    s_add_u32 s24, s23, 0
    buffer_load_dwordx4 v12, s[12:15], s24 offen offset:0 lds
    buffer_load_dwordx4 v13, s[12:15], s24 offen offset:1024 lds
    buffer_load_dwordx4 v14, s[12:15], s24 offen offset:2048 lds
    buffer_load_dwordx4 v15, s[12:15], s24 offen offset:3072 lds
    s_mov_b32 m0, 135168
    s_add_u32 s24, s23, 122880
    buffer_load_dwordx4 v12, s[12:15], s24 offen offset:0 lds
    buffer_load_dwordx4 v13, s[12:15], s24 offen offset:1024 lds
    buffer_load_dwordx4 v14, s[12:15], s24 offen offset:2048 lds
    buffer_load_dwordx4 v15, s[12:15], s24 offen offset:3072 lds
    s_mov_b32 m0, 77824
    s_add_u32 s24, s22, 122880
    buffer_load_dwordx4 v8, s[8:11], s24 offen offset:0 lds
    buffer_load_dwordx4 v9, s[8:11], s24 offen offset:1024 lds
    buffer_load_dwordx4 v10, s[8:11], s24 offen offset:2048 lds
    buffer_load_dwordx4 v11, s[8:11], s24 offen offset:3072 lds
    s_add_u32 s21, s21, 1
    s_cmp_eq_u32 s21, 10
    s_cselect_b32 s21, 0, s21
    s_lshl_b32 s22, s21, 7
    s_add_u32 s22, s22, s19
    s_mul_i32 s23, s21, 245760
    s_add_u32 s23, s23, s20
    s_mov_b32 m0, 139264
    s_add_u32 s24, s23, 0
    buffer_load_dwordx4 v12, s[12:15], s24 offen offset:0 lds
    buffer_load_dwordx4 v13, s[12:15], s24 offen offset:1024 lds
    buffer_load_dwordx4 v14, s[12:15], s24 offen offset:2048 lds
    buffer_load_dwordx4 v15, s[12:15], s24 offen offset:3072 lds
    s_mov_b32 m0, 143360
    s_add_u32 s24, s23, 122880
    buffer_load_dwordx4 v12, s[12:15], s24 offen offset:0 lds
    buffer_load_dwordx4 v13, s[12:15], s24 offen offset:1024 lds
    buffer_load_dwordx4 v14, s[12:15], s24 offen offset:2048 lds
    buffer_load_dwordx4 v15, s[12:15], s24 offen offset:3072 lds
    s_mov_b32 m0, 94208
    s_add_u32 s24, s22, 122880
    buffer_load_dwordx4 v8, s[8:11], s24 offen offset:0 lds
    buffer_load_dwordx4 v9, s[8:11], s24 offen offset:1024 lds
    buffer_load_dwordx4 v10, s[8:11], s24 offen offset:2048 lds
    buffer_load_dwordx4 v11, s[8:11], s24 offen offset:3072 lds
    s_add_u32 s21, s21, 1
    s_cmp_eq_u32 s21, 10
    s_cselect_b32 s21, 0, s21
    s_lshl_b32 s22, s21, 7
    s_add_u32 s22, s22, s19
    s_mul_i32 s23, s21, 245760
    s_add_u32 s23, s23, s20
    s_mov_b32 m0, 147456
    s_add_u32 s24, s23, 0
    buffer_load_dwordx4 v12, s[12:15], s24 offen offset:0 lds
    buffer_load_dwordx4 v13, s[12:15], s24 offen offset:1024 lds
    buffer_load_dwordx4 v14, s[12:15], s24 offen offset:2048 lds
    buffer_load_dwordx4 v15, s[12:15], s24 offen offset:3072 lds
    s_mov_b32 m0, 151552
    s_add_u32 s24, s23, 122880
    buffer_load_dwordx4 v12, s[12:15], s24 offen offset:0 lds
    buffer_load_dwordx4 v13, s[12:15], s24 offen offset:1024 lds
    buffer_load_dwordx4 v14, s[12:15], s24 offen offset:2048 lds
    buffer_load_dwordx4 v15, s[12:15], s24 offen offset:3072 lds
    s_mov_b32 m0, 110592
    s_add_u32 s24, s22, 122880
    buffer_load_dwordx4 v8, s[8:11], s24 offen offset:0 lds
    buffer_load_dwordx4 v9, s[8:11], s24 offen offset:1024 lds
    buffer_load_dwordx4 v10, s[8:11], s24 offen offset:2048 lds
    buffer_load_dwordx4 v11, s[8:11], s24 offen offset:3072 lds
    s_add_u32 s21, s21, 1
    s_cmp_eq_u32 s21, 10
    s_cselect_b32 s21, 0, s21
    s_waitcnt vmcnt(24)
    s_barrier
    s_lshl_b32 s22, s21, 7
    s_add_u32 s22, s22, s19
    s_mul_i32 s23, s21, 245760
    s_add_u32 s23, s23, s20
    s_mov_b32 m0, 155648
    s_add_u32 s24, s23, 0
    buffer_load_dwordx4 v12, s[12:15], s24 offen offset:0 lds
    buffer_load_dwordx4 v13, s[12:15], s24 offen offset:1024 lds
    buffer_load_dwordx4 v14, s[12:15], s24 offen offset:2048 lds
    buffer_load_dwordx4 v15, s[12:15], s24 offen offset:3072 lds
    s_mov_b32 m0, 159744
    s_add_u32 s24, s23, 122880
    buffer_load_dwordx4 v12, s[12:15], s24 offen offset:0 lds
    buffer_load_dwordx4 v13, s[12:15], s24 offen offset:1024 lds
    buffer_load_dwordx4 v14, s[12:15], s24 offen offset:2048 lds
    buffer_load_dwordx4 v15, s[12:15], s24 offen offset:3072 lds
    s_mov_b32 m0, 126976
    s_add_u32 s24, s22, 122880
    buffer_load_dwordx4 v8, s[8:11], s24 offen offset:0 lds
    buffer_load_dwordx4 v9, s[8:11], s24 offen offset:1024 lds
    buffer_load_dwordx4 v10, s[8:11], s24 offen offset:2048 lds
    buffer_load_dwordx4 v11, s[8:11], s24 offen offset:3072 lds
    s_add_u32 s21, s21, 1
    s_cmp_eq_u32 s21, 10
    s_cselect_b32 s21, 0, s21
    s_lshl_b32 s26, s18, 4
    s_add_u32 s26, s26, s17
    s_add_u32 s26, s26, 240
    s_and_b32 s28, s26, 31
    s_lshr_b32 s29, s26, 5
    s_mul_i32 s26, s28, 81920
    s_lshl_b32 s30, s29, 7
    s_add_u32 s26, s26, s30
    s_lshl_b32 s27, s29, 18
    s_lshl_b32 s28, s28, 7
    s_sub_u32 s27, s27, s28
    s_add_u32 s27, s27, 20975488
    s_cmp_ge_u32 s18, 5
    s_cselect_b32 s42, 0, 2621440
    s_mov_b32 s43, 0x00020000
    v_lshrrev_b32 v18, 3, v2
    v_and_b32 v19, 7, v2
    v_mul_u32_u24 v24, 1280, v18
    v_lshl_add_u32 v24, v19, 4, v24
    v_lshlrev_b32 v28, 12, v18
    v_lshl_add_u32 v28, v19, 4, v28
    v_xor_b32 v20, v18, v19
    v_lshlrev_b32 v20, 4, v20
    v_lshl_add_u32 v27, v18, 7, v20
    v_add_u32 v27, 131072, v27
    v_lshlrev_b32 v19, 4, v19
    v_lshl_add_u32 v26, v2, 7, v19
    v_add_u32 v26, 131072, v26
    v_bfe_u32 v18, v2, 2, 2
    v_sub_u32 v18, 3, v18
    v_lshlrev_b32 v18, 7, v18
    v_lshrrev_b32 v19, 4, v2
    v_lshl_add_u32 v18, v19, 5, v18
    v_and_b32 v19, 3, v2
    v_lshl_add_u32 v18, v19, 3, v18
    v_add_u32 v25, 131072, v18
    s_mov_b32 s36, s34
    s_mov_b32 s37, s35
    s_mov_b32 s38, 0x2000000
    s_mov_b32 s39, 0x00020000
    s_waitcnt vmcnt(24)
    s_barrier
    s_lshl_b32 s22, s21, 7
    s_add_u32 s22, s22, s19
    s_mul_i32 s23, s21, 245760
    s_add_u32 s23, s23, s20
    s_mov_b32 m0, 131072
    s_add_u32 s24, s23, 0
    buffer_load_dwordx4 v12, s[12:15], s24 offen offset:0 lds
    buffer_load_dwordx4 v13, s[12:15], s24 offen offset:1024 lds
    buffer_load_dwordx4 v14, s[12:15], s24 offen offset:2048 lds
    buffer_load_dwordx4 v15, s[12:15], s24 offen offset:3072 lds
    s_mov_b32 m0, 135168
    s_add_u32 s24, s23, 122880
    buffer_load_dwordx4 v12, s[12:15], s24 offen offset:0 lds
    buffer_load_dwordx4 v13, s[12:15], s24 offen offset:1024 lds
    buffer_load_dwordx4 v14, s[12:15], s24 offen offset:2048 lds
    buffer_load_dwordx4 v15, s[12:15], s24 offen offset:3072 lds
    s_mov_b32 m0, 77824
    s_add_u32 s24, s22, 122880
    buffer_load_dwordx4 v8, s[8:11], s24 offen offset:0 lds
    buffer_load_dwordx4 v9, s[8:11], s24 offen offset:1024 lds
    buffer_load_dwordx4 v10, s[8:11], s24 offen offset:2048 lds
    buffer_load_dwordx4 v11, s[8:11], s24 offen offset:3072 lds
    s_add_u32 s21, s21, 1
    s_cmp_eq_u32 s21, 10
    s_cselect_b32 s21, 0, s21
    s_waitcnt vmcnt(24)
    s_barrier
    s_lshl_b32 s22, s21, 7
    s_add_u32 s22, s22, s19
    s_mul_i32 s23, s21, 245760
    s_add_u32 s23, s23, s20
    s_mov_b32 m0, 139264
    s_add_u32 s24, s23, 0
    buffer_load_dwordx4 v12, s[12:15], s24 offen offset:0 lds
    buffer_load_dwordx4 v13, s[12:15], s24 offen offset:1024 lds
    buffer_load_dwordx4 v14, s[12:15], s24 offen offset:2048 lds
    buffer_load_dwordx4 v15, s[12:15], s24 offen offset:3072 lds
    s_mov_b32 m0, 143360
    s_add_u32 s24, s23, 122880
    buffer_load_dwordx4 v12, s[12:15], s24 offen offset:0 lds
    buffer_load_dwordx4 v13, s[12:15], s24 offen offset:1024 lds
    buffer_load_dwordx4 v14, s[12:15], s24 offen offset:2048 lds
    buffer_load_dwordx4 v15, s[12:15], s24 offen offset:3072 lds
    s_mov_b32 m0, 94208
    s_add_u32 s24, s22, 122880
    buffer_load_dwordx4 v8, s[8:11], s24 offen offset:0 lds
    buffer_load_dwordx4 v9, s[8:11], s24 offen offset:1024 lds
    buffer_load_dwordx4 v10, s[8:11], s24 offen offset:2048 lds
    buffer_load_dwordx4 v11, s[8:11], s24 offen offset:3072 lds
    s_add_u32 s21, s21, 1
    s_cmp_eq_u32 s21, 10
    s_cselect_b32 s21, 0, s21
    s_waitcnt vmcnt(24)
    s_barrier
    s_lshl_b32 s22, s21, 7
    s_add_u32 s22, s22, s19
    s_mul_i32 s23, s21, 245760
    s_add_u32 s23, s23, s20
    s_mov_b32 m0, 147456
    s_add_u32 s24, s23, 0
    buffer_load_dwordx4 v12, s[12:15], s24 offen offset:0 lds
    buffer_load_dwordx4 v13, s[12:15], s24 offen offset:1024 lds
    buffer_load_dwordx4 v14, s[12:15], s24 offen offset:2048 lds
    buffer_load_dwordx4 v15, s[12:15], s24 offen offset:3072 lds
    s_mov_b32 m0, 151552
    s_add_u32 s24, s23, 122880
    buffer_load_dwordx4 v12, s[12:15], s24 offen offset:0 lds
    buffer_load_dwordx4 v13, s[12:15], s24 offen offset:1024 lds
    buffer_load_dwordx4 v14, s[12:15], s24 offen offset:2048 lds
    buffer_load_dwordx4 v15, s[12:15], s24 offen offset:3072 lds
    s_mov_b32 m0, 110592
    s_add_u32 s24, s22, 122880
    buffer_load_dwordx4 v8, s[8:11], s24 offen offset:0 lds
    buffer_load_dwordx4 v9, s[8:11], s24 offen offset:1024 lds
    buffer_load_dwordx4 v10, s[8:11], s24 offen offset:2048 lds
    buffer_load_dwordx4 v11, s[8:11], s24 offen offset:3072 lds
    s_add_u32 s21, s21, 1
    s_cmp_eq_u32 s21, 10
    s_cselect_b32 s21, 0, s21
    s_waitcnt vmcnt(24)
    s_barrier
    s_lshl_b32 s22, s21, 7
    s_add_u32 s22, s22, s19
    s_mul_i32 s23, s21, 245760
    s_add_u32 s23, s23, s20
    s_mov_b32 m0, 155648
    s_add_u32 s24, s23, 0
    buffer_load_dwordx4 v12, s[12:15], s24 offen offset:0 lds
    buffer_load_dwordx4 v13, s[12:15], s24 offen offset:1024 lds
    buffer_load_dwordx4 v14, s[12:15], s24 offen offset:2048 lds
    buffer_load_dwordx4 v15, s[12:15], s24 offen offset:3072 lds
    s_mov_b32 m0, 159744
    s_add_u32 s24, s23, 122880
    buffer_load_dwordx4 v12, s[12:15], s24 offen offset:0 lds
    buffer_load_dwordx4 v13, s[12:15], s24 offen offset:1024 lds
    buffer_load_dwordx4 v14, s[12:15], s24 offen offset:2048 lds
    buffer_load_dwordx4 v15, s[12:15], s24 offen offset:3072 lds
    s_mov_b32 m0, 126976
    s_add_u32 s24, s22, 122880
    buffer_load_dwordx4 v8, s[8:11], s24 offen offset:0 lds
    buffer_load_dwordx4 v9, s[8:11], s24 offen offset:1024 lds
    buffer_load_dwordx4 v10, s[8:11], s24 offen offset:2048 lds
    buffer_load_dwordx4 v11, s[8:11], s24 offen offset:3072 lds
    s_add_u32 s21, s21, 1
    s_cmp_eq_u32 s21, 10
    s_cselect_b32 s21, 0, s21
    s_waitcnt vmcnt(24)
    s_barrier
    s_lshl_b32 s22, s21, 7
    s_add_u32 s22, s22, s19
    s_mul_i32 s23, s21, 245760
    s_add_u32 s23, s23, s20
    s_mov_b32 m0, 131072
    s_add_u32 s24, s23, 0
    buffer_load_dwordx4 v12, s[12:15], s24 offen offset:0 lds
    buffer_load_dwordx4 v13, s[12:15], s24 offen offset:1024 lds
    buffer_load_dwordx4 v14, s[12:15], s24 offen offset:2048 lds
    buffer_load_dwordx4 v15, s[12:15], s24 offen offset:3072 lds
    s_mov_b32 m0, 135168
    s_add_u32 s24, s23, 122880
    buffer_load_dwordx4 v12, s[12:15], s24 offen offset:0 lds
    buffer_load_dwordx4 v13, s[12:15], s24 offen offset:1024 lds
    buffer_load_dwordx4 v14, s[12:15], s24 offen offset:2048 lds
    buffer_load_dwordx4 v15, s[12:15], s24 offen offset:3072 lds
    s_mov_b32 m0, 77824
    s_add_u32 s24, s22, 122880
    buffer_load_dwordx4 v8, s[8:11], s24 offen offset:0 lds
    buffer_load_dwordx4 v9, s[8:11], s24 offen offset:1024 lds
    buffer_load_dwordx4 v10, s[8:11], s24 offen offset:2048 lds
    buffer_load_dwordx4 v11, s[8:11], s24 offen offset:3072 lds
    s_add_u32 s21, s21, 1
    s_cmp_eq_u32 s21, 10
    s_cselect_b32 s21, 0, s21
    s_waitcnt vmcnt(24)
    s_barrier
    s_lshl_b32 s22, s21, 7
    s_add_u32 s22, s22, s19
    s_mul_i32 s23, s21, 245760
    s_add_u32 s23, s23, s20
    s_mov_b32 m0, 139264
    s_add_u32 s24, s23, 0
    buffer_load_dwordx4 v12, s[12:15], s24 offen offset:0 lds
    buffer_load_dwordx4 v13, s[12:15], s24 offen offset:1024 lds
    buffer_load_dwordx4 v14, s[12:15], s24 offen offset:2048 lds
    buffer_load_dwordx4 v15, s[12:15], s24 offen offset:3072 lds
    s_mov_b32 m0, 143360
    s_add_u32 s24, s23, 122880
    buffer_load_dwordx4 v12, s[12:15], s24 offen offset:0 lds
    buffer_load_dwordx4 v13, s[12:15], s24 offen offset:1024 lds
    buffer_load_dwordx4 v14, s[12:15], s24 offen offset:2048 lds
    buffer_load_dwordx4 v15, s[12:15], s24 offen offset:3072 lds
    s_mov_b32 m0, 94208
    s_add_u32 s24, s22, 122880
    buffer_load_dwordx4 v8, s[8:11], s24 offen offset:0 lds
    buffer_load_dwordx4 v9, s[8:11], s24 offen offset:1024 lds
    buffer_load_dwordx4 v10, s[8:11], s24 offen offset:2048 lds
    buffer_load_dwordx4 v11, s[8:11], s24 offen offset:3072 lds
    s_add_u32 s21, s21, 1
    s_cmp_eq_u32 s21, 10
    s_cselect_b32 s21, 0, s21
    s_mul_i32 s23, s21, 245760
    s_add_u32 s23, s23, s46
    s_mov_b32 m0, 45056
    s_add_u32 s24, s23, 122880
    buffer_load_dwordx4 v12, s[12:15], s24 offen offset:0 lds
    buffer_load_dwordx4 v13, s[12:15], s24 offen offset:1024 lds
    buffer_load_dwordx4 v14, s[12:15], s24 offen offset:2048 lds
    buffer_load_dwordx4 v15, s[12:15], s24 offen offset:3072 lds
    s_add_u32 s21, s21, 1
    s_cmp_eq_u32 s21, 10
    s_cselect_b32 s21, 0, s21
    s_mul_i32 s23, s21, 245760
    s_add_u32 s23, s23, s46
    s_mov_b32 m0, 53248
    s_add_u32 s24, s23, 122880
    buffer_load_dwordx4 v12, s[12:15], s24 offen offset:0 lds
    buffer_load_dwordx4 v13, s[12:15], s24 offen offset:1024 lds
    buffer_load_dwordx4 v14, s[12:15], s24 offen offset:2048 lds
    buffer_load_dwordx4 v15, s[12:15], s24 offen offset:3072 lds
    s_add_u32 s21, s21, 1
    s_cmp_eq_u32 s21, 10
    s_cselect_b32 s21, 0, s21
    s_mul_i32 s23, s21, 245760
    s_add_u32 s23, s23, s46
    s_mov_b32 m0, 61440
    s_add_u32 s24, s23, 122880
    buffer_load_dwordx4 v12, s[12:15], s24 offen offset:0 lds
    buffer_load_dwordx4 v13, s[12:15], s24 offen offset:1024 lds
    buffer_load_dwordx4 v14, s[12:15], s24 offen offset:2048 lds
    buffer_load_dwordx4 v15, s[12:15], s24 offen offset:3072 lds
    s_add_u32 s21, s21, 1
    s_cmp_eq_u32 s21, 10
    s_cselect_b32 s21, 0, s21
    s_waitcnt vmcnt(36)
    s_barrier
    s_mul_i32 s23, s21, 245760
    s_add_u32 s23, s23, s46
    s_mov_b32 m0, 102400
    s_add_u32 s24, s23, 122880
    buffer_load_dwordx4 v12, s[12:15], s24 offen offset:0 lds
    buffer_load_dwordx4 v13, s[12:15], s24 offen offset:1024 lds
    buffer_load_dwordx4 v14, s[12:15], s24 offen offset:2048 lds
    buffer_load_dwordx4 v15, s[12:15], s24 offen offset:3072 lds
    s_add_u32 s21, s21, 1
    s_cmp_eq_u32 s21, 10
    s_cselect_b32 s21, 0, s21
    s_mul_i32 s23, s21, 245760
    s_add_u32 s23, s23, s46
    s_mov_b32 m0, 110592
    s_add_u32 s24, s23, 122880
    buffer_load_dwordx4 v12, s[12:15], s24 offen offset:0 lds
    buffer_load_dwordx4 v13, s[12:15], s24 offen offset:1024 lds
    buffer_load_dwordx4 v14, s[12:15], s24 offen offset:2048 lds
    buffer_load_dwordx4 v15, s[12:15], s24 offen offset:3072 lds
    s_add_u32 s21, s21, 1
    s_cmp_eq_u32 s21, 10
    s_cselect_b32 s21, 0, s21
    s_mul_i32 s23, s21, 245760
    s_add_u32 s23, s23, s46
    s_mov_b32 m0, 151552
    s_add_u32 s24, s23, 122880
    buffer_load_dwordx4 v12, s[12:15], s24 offen offset:0 lds
    buffer_load_dwordx4 v13, s[12:15], s24 offen offset:1024 lds
    buffer_load_dwordx4 v14, s[12:15], s24 offen offset:2048 lds
    buffer_load_dwordx4 v15, s[12:15], s24 offen offset:3072 lds
    s_add_u32 s21, s21, 1
    s_cmp_eq_u32 s21, 10
    s_cselect_b32 s21, 0, s21
    s_waitcnt vmcnt(36)
    s_barrier
    s_mul_i32 s23, s21, 245760
    s_add_u32 s23, s23, s46
    s_mov_b32 m0, 118784
    s_add_u32 s24, s23, 122880
    buffer_load_dwordx4 v12, s[12:15], s24 offen offset:0 lds
    buffer_load_dwordx4 v13, s[12:15], s24 offen offset:1024 lds
    buffer_load_dwordx4 v14, s[12:15], s24 offen offset:2048 lds
    buffer_load_dwordx4 v15, s[12:15], s24 offen offset:3072 lds
    s_add_u32 s21, s21, 1
    s_cmp_eq_u32 s21, 10
    s_cselect_b32 s21, 0, s21
    s_mul_i32 s23, s21, 245760
    s_add_u32 s23, s23, s46
    s_mov_b32 m0, 126976
    s_add_u32 s24, s23, 122880
    buffer_load_dwordx4 v12, s[12:15], s24 offen offset:0 lds
    buffer_load_dwordx4 v13, s[12:15], s24 offen offset:1024 lds
    buffer_load_dwordx4 v14, s[12:15], s24 offen offset:2048 lds
    buffer_load_dwordx4 v15, s[12:15], s24 offen offset:3072 lds
    s_add_u32 s21, s21, 1
    s_cmp_eq_u32 s21, 10
    s_cselect_b32 s21, 0, s21
    s_mul_i32 s23, s21, 245760
    s_add_u32 s23, s23, s46
    s_mov_b32 m0, 159744
    s_add_u32 s24, s23, 122880
    buffer_load_dwordx4 v12, s[12:15], s24 offen offset:0 lds
    buffer_load_dwordx4 v13, s[12:15], s24 offen offset:1024 lds
    buffer_load_dwordx4 v14, s[12:15], s24 offen offset:2048 lds
    buffer_load_dwordx4 v15, s[12:15], s24 offen offset:3072 lds
    s_add_u32 s21, s21, 1
    s_cmp_eq_u32 s21, 10
    s_cselect_b32 s21, 0, s21
    s_waitcnt vmcnt(36)
    s_barrier
    s_mul_i32 s23, s21, 245760
    s_add_u32 s23, s23, s46
    s_mov_b32 m0, 69632
    s_add_u32 s24, s23, 122880
    buffer_load_dwordx4 v12, s[12:15], s24 offen offset:0 lds
    buffer_load_dwordx4 v13, s[12:15], s24 offen offset:1024 lds
    buffer_load_dwordx4 v14, s[12:15], s24 offen offset:2048 lds
    buffer_load_dwordx4 v15, s[12:15], s24 offen offset:3072 lds
    s_add_u32 s21, s21, 1
    s_cmp_eq_u32 s21, 10
    s_cselect_b32 s21, 0, s21
    s_waitcnt vmcnt(28)
    s_barrier
    s_waitcnt vmcnt(16)
    s_barrier
    s_waitcnt vmcnt(0)
    s_barrier
    s_endpgm
SP_entry:
    s_cmp_ge_u32 s16, 5
    s_cbranch_scc1 CH_entry
KG_entry:
    s_load_dwordx8 s[40:47], s[0:1], 32
    s_load_dwordx4 s[48:51], s[0:1], 64
    s_load_dwordx4 s[52:55], s[0:1], 80
    s_load_dwordx2 s[64:65], s[0:1], 24
    s_mov_b64 s[56:57], 1
    s_lshl_b32 s20, s18, 4
    s_add_u32 s20, s20, s17
    s_lshl_b32 s20, s20, 1
    s_add_u32 s20, s20, s16
    s_sub_u32 s20, s20, 2
    s_mul_i32 s19, s17, 10
    s_add_u32 s19, s19, s16
    s_add_u32 s19, s19, 480
    s_cmp_eq_u32 s18, 15
    s_cselect_b32 s19, s19, s20
    s_cselect_b32 s21, 0, 2
    s_cselect_b32 s22, 5, 2
    s_sub_u32 s21, s16, s21
    s_add_u32 s22, s22, s21
    s_mul_i32 s21, s21, 8704
    s_mul_i32 s22, s22, 8704
    s_sub_u32 s22, s22, 16384
    v_and_b32 v50, 31, v2
    v_lshrrev_b32 v51, 5, v2
    v_mul_u32_u24 v4, 272, v50
    v_lshlrev_b32 v50, 4, v50
    v_lshl_add_u32 v4, v51, 4, v4
    v_lshl_add_u32 v5, v51, 9, v50
    v_add_u32 v168, s22, v4
    v_add_u32 v4, s21, v4
    s_lshl_b32 s24, s19, 8
    v_lshl_add_u32 v48, v2, 2, s24
    s_lshl_b32 s24, s19, 1
    v_mov_b32 v49, s24
    s_lshl_b32 s26, s19, 11
    s_add_u32 s26, s26, 16777216
    s_waitcnt lgkmcnt(0)
    global_load_ushort v14, v49, s[52:53]
    global_load_ushort v1, v49, s[54:55]
    global_load_dword v8, v48, s[40:41]
    global_load_dword v9, v48, s[42:43]
    global_load_dword v10, v48, s[44:45]
    global_load_dword v11, v48, s[46:47]
    global_load_dword v12, v48, s[48:49]
    global_load_dword v13, v48, s[50:51]
    s_mov_b32 s36, s34
    s_mov_b32 s37, s35
    s_mov_b32 s38, 0x2000000
    s_mov_b32 s39, 0x00020000
    s_cmp_eq_u32 s18, 15
    s_cbranch_scc0 KG_npf
    global_load_ushort v166, v49, s[52:53] offset:10
    global_load_ushort v167, v49, s[54:55] offset:10
    global_load_dword v160, v48, s[40:41] offset:1280
    global_load_dword v161, v48, s[42:43] offset:1280
    global_load_dword v162, v48, s[44:45] offset:1280
    global_load_dword v163, v48, s[46:47] offset:1280
    global_load_dword v164, v48, s[48:49] offset:1280
    global_load_dword v165, v48, s[50:51] offset:1280
KG_npf:
    s_lshl_b32 s59, s18, 4
    s_add_u32 s59, s59, s17
    s_sub_u32 s63, s18, 0
    s_cmp_eq_u32 s16, 3
    s_cselect_b32 s61, 240, 0
    s_cselect_b32 s62, 5, 15
    s_cselect_b32 s63, s63, s18
    s_add_u32 s59, s59, s61
    s_cmp_lt_u32 s63, s62
    s_cselect_b32 s58, 2621440, 0
    s_and_b32 s61, s59, 31
    s_lshr_b32 s62, s59, 5
    s_mul_i32 s59, s61, 81920
    s_lshl_b32 s63, s62, 7
    s_add_u32 s59, s59, s63
    s_lshl_b32 s60, s62, 18
    s_lshl_b32 s61, s61, 7
    s_sub_u32 s60, s60, s61
    s_add_u32 s60, s60, 20975488
    s_mov_b32 s66, s58
    s_mov_b32 s67, 0x00020000
    v_lshrrev_b32 v178, 3, v2
    v_and_b32 v179, 7, v2
    v_mul_u32_u24 v170, 1280, v178
    v_lshl_add_u32 v170, v179, 4, v170
    s_mov_b32 m0, s21
    s_nop 0
    buffer_load_dwordx4 v170, s[64:67], s59 offen offset:0 lds
    s_add_u32 s59, s59, 9216
    buffer_load_dwordx4 v170, s[64:67], s59 offen offset:1024 lds
    s_add_u32 s59, s59, 9216
    buffer_load_dwordx4 v170, s[64:67], s59 offen offset:2048 lds
    s_add_u32 s59, s59, 9216
    buffer_load_dwordx4 v170, s[64:67], s59 offen offset:3072 lds
    s_add_u32 s59, s59, 13312
    s_add_u32 m0, m0, 4096
    s_nop 0
    buffer_load_dwordx4 v170, s[64:67], s59 offen offset:0 lds
    s_add_u32 s59, s59, 9216
    buffer_load_dwordx4 v170, s[64:67], s59 offen offset:1024 lds
    s_add_u32 s59, s59, 9216
    buffer_load_dwordx4 v170, s[64:67], s59 offen offset:2048 lds
    s_add_u32 s59, s59, 9216
    buffer_load_dwordx4 v170, s[64:67], s59 offen offset:3072 lds
    s_cmp_eq_u32 s18, 15
    s_cbranch_scc1 KG_b1
    s_barrier
KG_b1:
    s_waitcnt vmcnt(8)
KG_round:
    v_lshlrev_b32 v14, 16, v14
    v_mul_f32 v56, 0x3fb8aa3b, v14
    v_mov_b32 v58, 0x3fb8aa3b
    v_fma_f32 v57, v14, v58, -v56
    v_fmac_f32 v57, 0x32a57060, v14
    v_exp_f32 v56, v56
    v_lshlrev_b32 v1, 16, v1
    v_mul_f32 v57, 0x3f317218, v57
    v_cndmask_b32 v1, 0, v1, s[56:57]
    v_fma_f32 v56, v56, v57, v56
    v_cvt_pk_bf16_f32 v56, v56, v56
    v_and_b32 v7, 0xffff0000, v56
    v_mul_f32 v15, 0x3fb8aa3b, v7
    v_mul_f32 v14, 0x3e22f983, v7
    v_lshlrev_b32 v114, 16, v8
    v_and_b32 v120, 0xffff0000, v8
    v_lshlrev_b32 v115, 16, v9
    v_and_b32 v121, 0xffff0000, v9
    v_lshlrev_b32 v116, 16, v10
    v_and_b32 v122, 0xffff0000, v10
    v_lshlrev_b32 v117, 16, v11
    v_and_b32 v123, 0xffff0000, v11
    v_lshlrev_b32 v118, 16, v12
    v_and_b32 v124, 0xffff0000, v12
    v_lshlrev_b32 v119, 16, v13
    v_and_b32 v125, 0xffff0000, v13
    v_mul_f32 v114, v114, v15
    v_mul_f32 v120, v120, v15
    v_mul_f32 v115, v115, v14
    v_mul_f32 v121, v121, v14
    v_mul_f32 v146, 32.0, v114
    v_mul_f32 v152, 32.0, v120
    v_mul_f32 v147, 32.0, v115
    v_mul_f32 v153, 32.0, v121
    v_exp_f32 v114, v114
    s_cmp_eq_u32 s18, 15
    s_cbranch_scc1 KG_b2
    s_barrier
KG_b2:
    v_exp_f32 v120, v120
    v_fract_f32 v115, v115
    v_fract_f32 v121, v121
    v_exp_f32 v146, v146
    v_exp_f32 v152, v152
    v_fract_f32 v147, v147
    v_fract_f32 v153, v153
    v_cos_f32 v130, v115
    v_cos_f32 v134, v121
    v_mul_f32 v148, v118, v116
    v_mul_f32 v154, v124, v122
    v_sin_f32 v131, v115
    v_sin_f32 v135, v121
    v_mul_f32 v149, v118, v117
    v_mul_f32 v155, v124, v123
    v_cos_f32 v138, v147
    v_cos_f32 v142, v153
    v_fma_f32 v148, -v119, v117, v148
    v_fma_f32 v154, -v125, v123, v154
    v_sin_f32 v139, v147
    v_sin_f32 v143, v153
    v_fmac_f32 v149, v119, v116
    v_fmac_f32 v155, v125, v122
    v_mul_f32 v130, v130, v114
    v_mul_f32 v134, v134, v120
    v_mul_f32 v131, v131, v114
    v_mul_f32 v135, v135, v120
    v_cvt_pk_f16_f32 v32, v148, -v149
    v_cvt_pk_f16_f32 v33, v154, -v155
    v_mul_f32 v138, v138, v146
    v_mul_f32 v142, v142, v152
    v_mul_f32 v139, v139, v146
    v_mul_f32 v143, v143, v152
    v_cvt_pk_f16_f32 v16, v130, v131
    v_cvt_pk_f16_f32 v104, v138, v139
    v_cvt_pk_f16_f32 v17, v134, v135
    v_cvt_pk_f16_f32 v105, v142, v143
    v_mul_f32 v150, v131, v131
    s_cmp_eq_u32 s18, 15
    s_cbranch_scc1 KG_b3
    s_barrier
KG_b3:
    v_mul_f32 v151, v139, v139
    v_mul_f32 v156, v135, v135
    v_mul_f32 v157, v143, v143
    v_add_f32 v133, v130, v130
    v_add_f32 v141, v138, v138
    v_add_f32 v137, v134, v134
    v_add_f32 v145, v142, v142
    v_fma_f32 v132, v130, v130, -v150
    v_fma_f32 v140, v138, v138, -v151
    v_fma_f32 v136, v134, v134, -v156
    v_fma_f32 v144, v142, v142, -v157
    v_mul_f32 v133, v133, v131
    v_mul_f32 v141, v141, v139
    v_mul_f32 v137, v137, v135
    v_mul_f32 v145, v145, v143
    v_cvt_pk_f16_f32 v18, v132, v133
    v_cvt_pk_f16_f32 v112, v140, v141
    v_cvt_pk_f16_f32 v19, v136, v137
    v_cvt_pk_f16_f32 v113, v144, v145
    v_mul_f32 v150, v133, v133
    v_mul_f32 v151, v141, v141
    v_mul_f32 v156, v137, v137
    v_mul_f32 v157, v145, v145
    v_add_f32 v131, v132, v132
    v_add_f32 v139, v140, v140
    v_add_f32 v135, v136, v136
    v_add_f32 v143, v144, v144
    v_fma_f32 v130, v132, v132, -v150
    v_fma_f32 v138, v140, v140, -v151
    v_fma_f32 v134, v136, v136, -v156
    v_fma_f32 v142, v144, v144, -v157
    v_mul_f32 v131, v131, v133
    v_mul_f32 v139, v139, v141
    v_mul_f32 v135, v135, v137
    v_mul_f32 v143, v143, v145
    v_cvt_pk_f16_f32 v20, v130, v131
    v_cvt_pk_f16_f32 v128, v138, v139
    v_cvt_pk_f16_f32 v21, v134, v135
    s_cmp_eq_u32 s18, 15
    s_cbranch_scc1 KG_b4
    s_barrier
KG_b4:
    v_cvt_pk_f16_f32 v129, v142, v143
    v_mul_f32 v150, v131, v131
    v_mul_f32 v151, v139, v139
    v_mul_f32 v156, v135, v135
    v_mul_f32 v157, v143, v143
    v_add_f32 v133, v130, v130
    v_add_f32 v141, v138, v138
    v_add_f32 v137, v134, v134
    v_add_f32 v145, v142, v142
    v_fma_f32 v132, v130, v130, -v150
    v_fma_f32 v140, v138, v138, -v151
    v_fma_f32 v136, v134, v134, -v156
    v_fma_f32 v144, v142, v142, -v157
    v_mul_f32 v133, v133, v131
    v_mul_f32 v141, v141, v139
    v_mul_f32 v137, v137, v135
    v_mul_f32 v145, v145, v143
    v_cvt_pk_f16_f32 v98, v132, v133
    v_cvt_pk_f16_f32 v22, v140, v141
    v_cvt_pk_f16_f32 v99, v136, v137
    v_cvt_pk_f16_f32 v23, v144, v145
    v_mul_f32 v150, v133, v133
    v_mul_f32 v151, v141, v141
    v_mul_f32 v156, v137, v137
    v_mul_f32 v157, v145, v145
    v_add_f32 v131, v132, v132
    v_add_f32 v139, v140, v140
    v_add_f32 v135, v136, v136
    v_add_f32 v143, v144, v144
    v_fma_f32 v130, v132, v132, -v150
    v_fma_f32 v138, v140, v140, -v151
    v_fma_f32 v134, v136, v136, -v156
    v_fma_f32 v142, v144, v144, -v157
    v_mul_f32 v131, v131, v133
    v_mul_f32 v139, v139, v141
    v_mul_f32 v135, v135, v137
    v_mul_f32 v143, v143, v145
    v_cvt_pk_f16_f32 v100, v130, v131
    s_cmp_eq_u32 s18, 15
    s_cbranch_scc1 KG_b5
    s_barrier
KG_b5:
    v_cvt_pk_f16_f32 v24, v138, v139
    v_cvt_pk_f16_f32 v101, v134, v135
    v_cvt_pk_f16_f32 v25, v142, v143
    v_mul_f32 v151, v139, v139
    v_mul_f32 v157, v143, v143
    v_add_f32 v141, v138, v138
    v_add_f32 v145, v142, v142
    v_fma_f32 v140, v138, v138, -v151
    v_fma_f32 v144, v142, v142, -v157
    v_mul_f32 v141, v141, v139
    v_mul_f32 v145, v145, v143
    v_cvt_pk_f16_f32 v26, v140, v141
    v_cvt_pk_f16_f32 v27, v144, v145
    v_pk_mul_f16 v28, v32, v16 op_sel_hi:[1,0]
    v_pk_mul_f16 v29, v33, v17 op_sel_hi:[1,0]
    v_pk_mul_f16 v30, v32, v18 op_sel_hi:[1,0]
    v_pk_mul_f16 v31, v33, v19 op_sel_hi:[1,0]
    v_pk_fma_f16 v34, v32, v16, v28 op_sel:[1,1,0] op_sel_hi:[0,1,1] neg_hi:[1,0,0]
    v_pk_fma_f16 v35, v33, v17, v29 op_sel:[1,1,0] op_sel_hi:[0,1,1] neg_hi:[1,0,0]
    v_pk_fma_f16 v36, v32, v18, v30 op_sel:[1,1,0] op_sel_hi:[0,1,1] neg_hi:[1,0,0]
    v_pk_fma_f16 v37, v33, v19, v31 op_sel:[1,1,0] op_sel_hi:[0,1,1] neg_hi:[1,0,0]
    v_pk_mul_f16 v28, v34, v18 op_sel_hi:[1,0]
    v_pk_mul_f16 v29, v35, v19 op_sel_hi:[1,0]
    v_pk_mul_f16 v30, v32, v20 op_sel_hi:[1,0]
    v_pk_mul_f16 v31, v33, v21 op_sel_hi:[1,0]
    v_pk_fma_f16 v38, v34, v18, v28 op_sel:[1,1,0] op_sel_hi:[0,1,1] neg_hi:[1,0,0]
    v_pk_fma_f16 v39, v35, v19, v29 op_sel:[1,1,0] op_sel_hi:[0,1,1] neg_hi:[1,0,0]
    v_pk_fma_f16 v40, v32, v20, v30 op_sel:[1,1,0] op_sel_hi:[0,1,1] neg_hi:[1,0,0]
    v_pk_fma_f16 v41, v33, v21, v31 op_sel:[1,1,0] op_sel_hi:[0,1,1] neg_hi:[1,0,0]
    v_pk_mul_f16 v28, v34, v20 op_sel_hi:[1,0]
    v_pk_mul_f16 v29, v35, v21 op_sel_hi:[1,0]
    v_pk_mul_f16 v30, v36, v20 op_sel_hi:[1,0]
    v_pk_mul_f16 v31, v37, v21 op_sel_hi:[1,0]
    v_pk_fma_f16 v42, v34, v20, v28 op_sel:[1,1,0] op_sel_hi:[0,1,1] neg_hi:[1,0,0]
    v_pk_fma_f16 v43, v35, v21, v29 op_sel:[1,1,0] op_sel_hi:[0,1,1] neg_hi:[1,0,0]
    v_pk_fma_f16 v44, v36, v20, v30 op_sel:[1,1,0] op_sel_hi:[0,1,1] neg_hi:[1,0,0]
    v_pk_fma_f16 v45, v37, v21, v31 op_sel:[1,1,0] op_sel_hi:[0,1,1] neg_hi:[1,0,0]
    v_pk_mul_f16 v28, v38, v20 op_sel_hi:[1,0]
    s_cmp_eq_u32 s18, 15
    s_cbranch_scc1 KG_b6
    s_barrier
KG_b6:
    v_pk_mul_f16 v29, v39, v21 op_sel_hi:[1,0]
    v_pk_mul_f16 v30, v32, v98 op_sel_hi:[1,0]
    v_pk_mul_f16 v31, v33, v99 op_sel_hi:[1,0]
    v_pk_fma_f16 v46, v38, v20, v28 op_sel:[1,1,0] op_sel_hi:[0,1,1] neg_hi:[1,0,0]
    v_pk_fma_f16 v47, v39, v21, v29 op_sel:[1,1,0] op_sel_hi:[0,1,1] neg_hi:[1,0,0]
    v_pk_fma_f16 v48, v32, v98, v30 op_sel:[1,1,0] op_sel_hi:[0,1,1] neg_hi:[1,0,0]
    v_pk_fma_f16 v49, v33, v99, v31 op_sel:[1,1,0] op_sel_hi:[0,1,1] neg_hi:[1,0,0]
    v_pk_mul_f16 v28, v32, v22 op_sel_hi:[1,0]
    v_pk_mul_f16 v29, v33, v23 op_sel_hi:[1,0]
    v_pk_mul_f16 v30, v36, v22 op_sel_hi:[1,0]
    v_pk_mul_f16 v31, v37, v23 op_sel_hi:[1,0]
    v_pk_fma_f16 v50, v32, v22, v28 op_sel:[1,1,0] op_sel_hi:[0,1,1] neg_hi:[1,0,0]
    v_pk_fma_f16 v51, v33, v23, v29 op_sel:[1,1,0] op_sel_hi:[0,1,1] neg_hi:[1,0,0]
    v_pk_fma_f16 v52, v36, v22, v30 op_sel:[1,1,0] op_sel_hi:[0,1,1] neg_hi:[1,0,0]
    v_pk_fma_f16 v53, v37, v23, v31 op_sel:[1,1,0] op_sel_hi:[0,1,1] neg_hi:[1,0,0]
    v_pk_mul_f16 v28, v40, v22 op_sel_hi:[1,0]
    v_pk_mul_f16 v29, v41, v23 op_sel_hi:[1,0]
    v_pk_mul_f16 v30, v44, v22 op_sel_hi:[1,0]
    v_pk_mul_f16 v31, v45, v23 op_sel_hi:[1,0]
    v_pk_fma_f16 v54, v40, v22, v28 op_sel:[1,1,0] op_sel_hi:[0,1,1] neg_hi:[1,0,0]
    v_pk_fma_f16 v55, v41, v23, v29 op_sel:[1,1,0] op_sel_hi:[0,1,1] neg_hi:[1,0,0]
    v_pk_fma_f16 v56, v44, v22, v30 op_sel:[1,1,0] op_sel_hi:[0,1,1] neg_hi:[1,0,0]
    v_pk_fma_f16 v57, v45, v23, v31 op_sel:[1,1,0] op_sel_hi:[0,1,1] neg_hi:[1,0,0]
    v_pk_mul_f16 v28, v48, v22 op_sel_hi:[1,0]
    v_pk_mul_f16 v29, v49, v23 op_sel_hi:[1,0]
    v_pk_mul_f16 v30, v32, v24 op_sel_hi:[1,0]
    v_pk_mul_f16 v31, v33, v25 op_sel_hi:[1,0]
    v_pk_fma_f16 v58, v48, v22, v28 op_sel:[1,1,0] op_sel_hi:[0,1,1] neg_hi:[1,0,0]
    v_pk_fma_f16 v59, v49, v23, v29 op_sel:[1,1,0] op_sel_hi:[0,1,1] neg_hi:[1,0,0]
    v_pk_fma_f16 v60, v32, v24, v30 op_sel:[1,1,0] op_sel_hi:[0,1,1] neg_hi:[1,0,0]
    v_pk_fma_f16 v61, v33, v25, v31 op_sel:[1,1,0] op_sel_hi:[0,1,1] neg_hi:[1,0,0]
    v_pk_mul_f16 v28, v40, v24 op_sel_hi:[1,0]
    v_pk_mul_f16 v29, v41, v25 op_sel_hi:[1,0]
    v_pk_mul_f16 v30, v48, v24 op_sel_hi:[1,0]
    v_pk_mul_f16 v31, v49, v25 op_sel_hi:[1,0]
    v_pk_fma_f16 v62, v40, v24, v28 op_sel:[1,1,0] op_sel_hi:[0,1,1] neg_hi:[1,0,0]
    v_pk_fma_f16 v63, v41, v25, v29 op_sel:[1,1,0] op_sel_hi:[0,1,1] neg_hi:[1,0,0]
    v_pk_fma_f16 v64, v48, v24, v30 op_sel:[1,1,0] op_sel_hi:[0,1,1] neg_hi:[1,0,0]
    s_cmp_eq_u32 s18, 15
    s_cbranch_scc1 KG_b7
    s_barrier
KG_b7:
    v_pk_fma_f16 v65, v49, v25, v31 op_sel:[1,1,0] op_sel_hi:[0,1,1] neg_hi:[1,0,0]
    s_waitcnt vmcnt(0)
    s_cmp_eq_u32 s58, 0
    s_cbranch_scc1 KG_t1
    v_lshlrev_b32 v174, 12, v178
    v_lshl_add_u32 v174, v179, 4, v174
    v_xor_b32 v173, v178, v179
    v_lshlrev_b32 v173, 4, v173
    v_lshl_add_u32 v173, v178, 7, v173
    v_add_u32 v173, s21, v173
    v_lshlrev_b32 v179, 4, v179
    v_lshl_add_u32 v172, v2, 7, v179
    v_add_u32 v172, s21, v172
    v_bfe_u32 v178, v2, 2, 2
    v_sub_u32 v178, 3, v178
    v_lshlrev_b32 v178, 7, v178
    v_lshrrev_b32 v179, 4, v2
    v_lshl_add_u32 v178, v179, 5, v178
    v_and_b32 v179, 3, v2
    v_lshl_add_u32 v178, v179, 3, v178
    v_add_u32 v171, s21, v178
    ds_read_b64_tr_b16 v[180:181], v171 offset:7680
    ds_read_b64_tr_b16 v[182:183], v171 offset:7168
    ds_read_b64_tr_b16 v[184:185], v171 offset:6656
    ds_read_b64_tr_b16 v[186:187], v171 offset:6144
    ds_read_b64_tr_b16 v[188:189], v171 offset:5632
    ds_read_b64_tr_b16 v[190:191], v171 offset:5120
    ds_read_b64_tr_b16 v[192:193], v171 offset:4608
    ds_read_b64_tr_b16 v[194:195], v171 offset:4096
    ds_read_b64_tr_b16 v[196:197], v171 offset:3584
    ds_read_b64_tr_b16 v[198:199], v171 offset:3072
    ds_read_b64_tr_b16 v[200:201], v171 offset:2560
    ds_read_b64_tr_b16 v[202:203], v171 offset:2048
    ds_read_b64_tr_b16 v[204:205], v171 offset:1536
    ds_read_b64_tr_b16 v[206:207], v171 offset:1024
    ds_read_b64_tr_b16 v[208:209], v171 offset:512
    ds_read_b64_tr_b16 v[210:211], v171 offset:0
KG_t1:
    v_pk_mul_f16 v28, v50, v24 op_sel_hi:[1,0]
    v_pk_mul_f16 v29, v51, v25 op_sel_hi:[1,0]
    v_pk_mul_f16 v30, v54, v24 op_sel_hi:[1,0]
    v_pk_mul_f16 v31, v55, v25 op_sel_hi:[1,0]
    v_pk_fma_f16 v66, v50, v24, v28 op_sel:[1,1,0] op_sel_hi:[0,1,1] neg_hi:[1,0,0]
    v_pk_fma_f16 v67, v51, v25, v29 op_sel:[1,1,0] op_sel_hi:[0,1,1] neg_hi:[1,0,0]
    v_pk_fma_f16 v68, v54, v24, v30 op_sel:[1,1,0] op_sel_hi:[0,1,1] neg_hi:[1,0,0]
    v_pk_fma_f16 v69, v55, v25, v31 op_sel:[1,1,0] op_sel_hi:[0,1,1] neg_hi:[1,0,0]
    v_pk_mul_f16 v28, v58, v24 op_sel_hi:[1,0]
    v_pk_mul_f16 v29, v59, v25 op_sel_hi:[1,0]
    v_pk_mul_f16 v30, v32, v26 op_sel_hi:[1,0]
    v_pk_mul_f16 v31, v33, v27 op_sel_hi:[1,0]
    v_pk_fma_f16 v70, v58, v24, v28 op_sel:[1,1,0] op_sel_hi:[0,1,1] neg_hi:[1,0,0]
    v_pk_fma_f16 v71, v59, v25, v29 op_sel:[1,1,0] op_sel_hi:[0,1,1] neg_hi:[1,0,0]
    v_pk_fma_f16 v72, v32, v26, v30 op_sel:[1,1,0] op_sel_hi:[0,1,1] neg_hi:[1,0,0]
    v_pk_fma_f16 v73, v33, v27, v31 op_sel:[1,1,0] op_sel_hi:[0,1,1] neg_hi:[1,0,0]
    v_pk_mul_f16 v28, v48, v26 op_sel_hi:[1,0]
    v_pk_mul_f16 v29, v49, v27 op_sel_hi:[1,0]
    v_pk_mul_f16 v30, v50, v26 op_sel_hi:[1,0]
    v_pk_mul_f16 v31, v51, v27 op_sel_hi:[1,0]
    v_pk_fma_f16 v74, v48, v26, v28 op_sel:[1,1,0] op_sel_hi:[0,1,1] neg_hi:[1,0,0]
    v_pk_fma_f16 v75, v49, v27, v29 op_sel:[1,1,0] op_sel_hi:[0,1,1] neg_hi:[1,0,0]
    v_pk_fma_f16 v76, v50, v26, v30 op_sel:[1,1,0] op_sel_hi:[0,1,1] neg_hi:[1,0,0]
    v_pk_fma_f16 v77, v51, v27, v31 op_sel:[1,1,0] op_sel_hi:[0,1,1] neg_hi:[1,0,0]
    v_pk_mul_f16 v28, v58, v26 op_sel_hi:[1,0]
    v_pk_mul_f16 v29, v59, v27 op_sel_hi:[1,0]
    v_pk_mul_f16 v30, v60, v26 op_sel_hi:[1,0]
    v_pk_mul_f16 v31, v61, v27 op_sel_hi:[1,0]
    v_pk_fma_f16 v78, v58, v26, v28 op_sel:[1,1,0] op_sel_hi:[0,1,1] neg_hi:[1,0,0]
    v_pk_fma_f16 v79, v59, v27, v29 op_sel:[1,1,0] op_sel_hi:[0,1,1] neg_hi:[1,0,0]
    v_pk_fma_f16 v80, v60, v26, v30 op_sel:[1,1,0] op_sel_hi:[0,1,1] neg_hi:[1,0,0]
    v_pk_fma_f16 v81, v61, v27, v31 op_sel:[1,1,0] op_sel_hi:[0,1,1] neg_hi:[1,0,0]
    v_pk_mul_f16 v28, v64, v26 op_sel_hi:[1,0]
    v_pk_mul_f16 v29, v65, v27 op_sel_hi:[1,0]
    v_pk_mul_f16 v30, v66, v26 op_sel_hi:[1,0]
    v_pk_mul_f16 v31, v67, v27 op_sel_hi:[1,0]
    v_pk_fma_f16 v82, v64, v26, v28 op_sel:[1,1,0] op_sel_hi:[0,1,1] neg_hi:[1,0,0]
    s_cmp_eq_u32 s58, 0
    s_cbranch_scc1 KG_t2
    s_waitcnt lgkmcnt(0)
    ds_write_b128 v172, v[180:183]
    v_xor_b32 v177, 16, v172
    ds_write_b128 v177, v[184:187]
    v_xor_b32 v176, 32, v172
    ds_write_b128 v176, v[188:191]
    v_xor_b32 v177, 48, v172
    ds_write_b128 v177, v[192:195]
    v_xor_b32 v176, 64, v172
    ds_write_b128 v176, v[196:199]
    v_xor_b32 v177, 80, v172
    ds_write_b128 v177, v[200:203]
    v_xor_b32 v176, 96, v172
    ds_write_b128 v176, v[204:207]
    v_xor_b32 v177, 112, v172
    ds_write_b128 v177, v[208:211]
    ds_read_b128 v[212:215], v173 offset:0
    ds_read_b128 v[216:219], v173 offset:1024
    ds_read_b128 v[220:223], v173 offset:2048
    ds_read_b128 v[224:227], v173 offset:3072
    ds_read_b128 v[228:231], v173 offset:4096
    ds_read_b128 v[232:235], v173 offset:5120
    ds_read_b128 v[236:239], v173 offset:6144
    ds_read_b128 v[240:243], v173 offset:7168
KG_t2:
    s_cmp_eq_u32 s18, 15
    s_cbranch_scc1 KG_b8
    s_barrier
KG_b8:
    v_pk_fma_f16 v83, v65, v27, v29 op_sel:[1,1,0] op_sel_hi:[0,1,1] neg_hi:[1,0,0]
    v_pk_fma_f16 v84, v66, v26, v30 op_sel:[1,1,0] op_sel_hi:[0,1,1] neg_hi:[1,0,0]
    v_pk_fma_f16 v85, v67, v27, v31 op_sel:[1,1,0] op_sel_hi:[0,1,1] neg_hi:[1,0,0]
    v_pk_mul_f16 v28, v70, v26 op_sel_hi:[1,0]
    v_pk_mul_f16 v29, v71, v27 op_sel_hi:[1,0]
    v_pk_fma_f16 v86, v70, v26, v28 op_sel:[1,1,0] op_sel_hi:[0,1,1] neg_hi:[1,0,0]
    v_pk_fma_f16 v87, v71, v27, v29 op_sel:[1,1,0] op_sel_hi:[0,1,1] neg_hi:[1,0,0]
    v_mov_b32 v96, 0x3c00
    v_mov_b32 v97, 0x3c00
    v_pk_mul_f16 v28, v98, v100 op_sel_hi:[1,0]
    v_pk_mul_f16 v29, v99, v101 op_sel_hi:[1,0]
    v_pk_mul_f16 v30, v98, v104 op_sel_hi:[1,0]
    v_pk_mul_f16 v31, v99, v105 op_sel_hi:[1,0]
    v_pk_fma_f16 v102, v98, v100, v28 op_sel:[1,1,0] op_sel_hi:[0,1,1] neg_lo:[1,0,0]
    v_pk_fma_f16 v103, v99, v101, v29 op_sel:[1,1,0] op_sel_hi:[0,1,1] neg_lo:[1,0,0]
    v_pk_fma_f16 v106, v98, v104, v30 op_sel:[1,1,0] op_sel_hi:[0,1,1] neg_lo:[1,0,0]
    v_pk_fma_f16 v107, v99, v105, v31 op_sel:[1,1,0] op_sel_hi:[0,1,1] neg_lo:[1,0,0]
    v_pk_mul_f16 v28, v100, v104 op_sel_hi:[1,0]
    v_pk_mul_f16 v29, v101, v105 op_sel_hi:[1,0]
    s_cmp_eq_u32 s58, 0
    s_cbranch_scc1 KG_t3
    s_waitcnt lgkmcnt(0)
    buffer_store_dwordx4 v[212:215], v174, s[36:39], s60 offen sc1
    s_add_u32 s60, s60, 32768
    buffer_store_dwordx4 v[216:219], v174, s[36:39], s60 offen sc1
    s_add_u32 s60, s60, 32768
    buffer_store_dwordx4 v[220:223], v174, s[36:39], s60 offen sc1
    s_add_u32 s60, s60, 32768
    buffer_store_dwordx4 v[224:227], v174, s[36:39], s60 offen sc1
    s_add_u32 s60, s60, 32768
    buffer_store_dwordx4 v[228:231], v174, s[36:39], s60 offen sc1
    s_add_u32 s60, s60, 32768
    buffer_store_dwordx4 v[232:235], v174, s[36:39], s60 offen sc1
    s_add_u32 s60, s60, 32768
    buffer_store_dwordx4 v[236:239], v174, s[36:39], s60 offen sc1
    s_add_u32 s60, s60, 32768
    buffer_store_dwordx4 v[240:243], v174, s[36:39], s60 offen sc1
KG_t3:
    v_pk_mul_f16 v30, v98, v112 op_sel_hi:[1,0]
    v_pk_mul_f16 v31, v99, v113 op_sel_hi:[1,0]
    v_pk_fma_f16 v108, v100, v104, v28 op_sel:[1,1,0] op_sel_hi:[0,1,1] neg_lo:[1,0,0]
    v_pk_fma_f16 v109, v101, v105, v29 op_sel:[1,1,0] op_sel_hi:[0,1,1] neg_lo:[1,0,0]
    v_pk_fma_f16 v114, v98, v112, v30 op_sel:[1,1,0] op_sel_hi:[0,1,1] neg_lo:[1,0,0]
    v_pk_fma_f16 v115, v99, v113, v31 op_sel:[1,1,0] op_sel_hi:[0,1,1] neg_lo:[1,0,0]
    v_pk_mul_f16 v28, v100, v112 op_sel_hi:[1,0]
    v_pk_mul_f16 v29, v101, v113 op_sel_hi:[1,0]
    v_pk_mul_f16 v30, v104, v112 op_sel_hi:[1,0]
    v_pk_mul_f16 v31, v105, v113 op_sel_hi:[1,0]
    v_pk_fma_f16 v116, v100, v112, v28 op_sel:[1,1,0] op_sel_hi:[0,1,1] neg_lo:[1,0,0]
    v_pk_fma_f16 v117, v101, v113, v29 op_sel:[1,1,0] op_sel_hi:[0,1,1] neg_lo:[1,0,0]
    v_pk_fma_f16 v120, v104, v112, v30 op_sel:[1,1,0] op_sel_hi:[0,1,1] neg_lo:[1,0,0]
    v_pk_fma_f16 v121, v105, v113, v31 op_sel:[1,1,0] op_sel_hi:[0,1,1] neg_lo:[1,0,0]
    v_pk_mul_f16 v28, v102, v104 op_sel_hi:[1,0]
    v_pk_mul_f16 v29, v103, v105 op_sel_hi:[1,0]
    v_pk_mul_f16 v30, v102, v112 op_sel_hi:[1,0]
    v_pk_mul_f16 v31, v103, v113 op_sel_hi:[1,0]
    v_pk_fma_f16 v110, v102, v104, v28 op_sel:[1,1,0] op_sel_hi:[0,1,1] neg_lo:[1,0,0]
    s_cmp_eq_u32 s18, 15
    s_cbranch_scc1 KG_b9
    s_barrier
KG_b9:
    v_pk_fma_f16 v111, v103, v105, v29 op_sel:[1,1,0] op_sel_hi:[0,1,1] neg_lo:[1,0,0]
    v_pk_fma_f16 v118, v102, v112, v30 op_sel:[1,1,0] op_sel_hi:[0,1,1] neg_lo:[1,0,0]
    v_pk_fma_f16 v119, v103, v113, v31 op_sel:[1,1,0] op_sel_hi:[0,1,1] neg_lo:[1,0,0]
    v_pk_mul_f16 v28, v106, v112 op_sel_hi:[1,0]
    v_pk_mul_f16 v29, v107, v113 op_sel_hi:[1,0]
    v_pk_mul_f16 v30, v108, v112 op_sel_hi:[1,0]
    v_pk_mul_f16 v31, v109, v113 op_sel_hi:[1,0]
    v_pk_fma_f16 v122, v106, v112, v28 op_sel:[1,1,0] op_sel_hi:[0,1,1] neg_lo:[1,0,0]
    v_pk_fma_f16 v123, v107, v113, v29 op_sel:[1,1,0] op_sel_hi:[0,1,1] neg_lo:[1,0,0]
    v_pk_fma_f16 v124, v108, v112, v30 op_sel:[1,1,0] op_sel_hi:[0,1,1] neg_lo:[1,0,0]
    v_pk_fma_f16 v125, v109, v113, v31 op_sel:[1,1,0] op_sel_hi:[0,1,1] neg_lo:[1,0,0]
    v_pk_mul_f16 v28, v98, v128 op_sel_hi:[1,0]
    v_pk_mul_f16 v29, v99, v129 op_sel_hi:[1,0]
    v_pk_mul_f16 v30, v100, v128 op_sel_hi:[1,0]
    v_pk_mul_f16 v31, v101, v129 op_sel_hi:[1,0]
    v_pk_fma_f16 v130, v98, v128, v28 op_sel:[1,1,0] op_sel_hi:[0,1,1] neg_lo:[1,0,0]
    v_pk_fma_f16 v131, v99, v129, v29 op_sel:[1,1,0] op_sel_hi:[0,1,1] neg_lo:[1,0,0]
    v_pk_fma_f16 v132, v100, v128, v30 op_sel:[1,1,0] op_sel_hi:[0,1,1] neg_lo:[1,0,0]
    v_pk_fma_f16 v133, v101, v129, v31 op_sel:[1,1,0] op_sel_hi:[0,1,1] neg_lo:[1,0,0]
    v_pk_mul_f16 v28, v110, v112 op_sel_hi:[1,0]
    v_pk_mul_f16 v29, v111, v113 op_sel_hi:[1,0]
    v_pk_mul_f16 v30, v102, v128 op_sel_hi:[1,0]
    v_pk_mul_f16 v31, v103, v129 op_sel_hi:[1,0]
    v_pk_fma_f16 v126, v110, v112, v28 op_sel:[1,1,0] op_sel_hi:[0,1,1] neg_lo:[1,0,0]
    v_pk_fma_f16 v127, v111, v113, v29 op_sel:[1,1,0] op_sel_hi:[0,1,1] neg_lo:[1,0,0]
    v_pk_fma_f16 v134, v102, v128, v30 op_sel:[1,1,0] op_sel_hi:[0,1,1] neg_lo:[1,0,0]
    v_pk_fma_f16 v135, v103, v129, v31 op_sel:[1,1,0] op_sel_hi:[0,1,1] neg_lo:[1,0,0]
    v_pk_mul_f16 v28, v104, v128 op_sel_hi:[1,0]
    v_pk_mul_f16 v29, v105, v129 op_sel_hi:[1,0]
    v_pk_mul_f16 v30, v106, v128 op_sel_hi:[1,0]
    v_pk_mul_f16 v31, v107, v129 op_sel_hi:[1,0]
    v_pk_fma_f16 v136, v104, v128, v28 op_sel:[1,1,0] op_sel_hi:[0,1,1] neg_lo:[1,0,0]
    v_pk_fma_f16 v137, v105, v129, v29 op_sel:[1,1,0] op_sel_hi:[0,1,1] neg_lo:[1,0,0]
    v_pk_fma_f16 v138, v106, v128, v30 op_sel:[1,1,0] op_sel_hi:[0,1,1] neg_lo:[1,0,0]
    v_pk_fma_f16 v139, v107, v129, v31 op_sel:[1,1,0] op_sel_hi:[0,1,1] neg_lo:[1,0,0]
    v_pk_mul_f16 v28, v108, v128 op_sel_hi:[1,0]
    v_pk_mul_f16 v29, v109, v129 op_sel_hi:[1,0]
    v_pk_mul_f16 v30, v110, v128 op_sel_hi:[1,0]
    s_cmp_eq_u32 s18, 15
    s_cbranch_scc1 KG_b10
    s_barrier
KG_b10:
    v_pk_mul_f16 v31, v111, v129 op_sel_hi:[1,0]
    v_pk_fma_f16 v140, v108, v128, v28 op_sel:[1,1,0] op_sel_hi:[0,1,1] neg_lo:[1,0,0]
    v_pk_fma_f16 v141, v109, v129, v29 op_sel:[1,1,0] op_sel_hi:[0,1,1] neg_lo:[1,0,0]
    v_pk_fma_f16 v142, v110, v128, v30 op_sel:[1,1,0] op_sel_hi:[0,1,1] neg_lo:[1,0,0]
    v_pk_fma_f16 v143, v111, v129, v31 op_sel:[1,1,0] op_sel_hi:[0,1,1] neg_lo:[1,0,0]
    v_pk_mul_f16 v28, v112, v128 op_sel_hi:[1,0]
    v_pk_mul_f16 v29, v113, v129 op_sel_hi:[1,0]
    v_pk_mul_f16 v30, v114, v128 op_sel_hi:[1,0]
    v_pk_mul_f16 v31, v115, v129 op_sel_hi:[1,0]
    v_pk_fma_f16 v144, v112, v128, v28 op_sel:[1,1,0] op_sel_hi:[0,1,1] neg_lo:[1,0,0]
    v_pk_fma_f16 v145, v113, v129, v29 op_sel:[1,1,0] op_sel_hi:[0,1,1] neg_lo:[1,0,0]
    v_pk_fma_f16 v146, v114, v128, v30 op_sel:[1,1,0] op_sel_hi:[0,1,1] neg_lo:[1,0,0]
    v_pk_fma_f16 v147, v115, v129, v31 op_sel:[1,1,0] op_sel_hi:[0,1,1] neg_lo:[1,0,0]
    v_pk_mul_f16 v28, v116, v128 op_sel_hi:[1,0]
    v_pk_mul_f16 v29, v117, v129 op_sel_hi:[1,0]
    v_pk_mul_f16 v30, v118, v128 op_sel_hi:[1,0]
    v_pk_mul_f16 v31, v119, v129 op_sel_hi:[1,0]
    v_pk_fma_f16 v148, v116, v128, v28 op_sel:[1,1,0] op_sel_hi:[0,1,1] neg_lo:[1,0,0]
    v_pk_fma_f16 v149, v117, v129, v29 op_sel:[1,1,0] op_sel_hi:[0,1,1] neg_lo:[1,0,0]
    v_pk_fma_f16 v150, v118, v128, v30 op_sel:[1,1,0] op_sel_hi:[0,1,1] neg_lo:[1,0,0]
    v_pk_fma_f16 v151, v119, v129, v31 op_sel:[1,1,0] op_sel_hi:[0,1,1] neg_lo:[1,0,0]
    v_pk_mul_f16 v28, v120, v128 op_sel_hi:[1,0]
    v_pk_mul_f16 v29, v121, v129 op_sel_hi:[1,0]
    v_pk_mul_f16 v30, v122, v128 op_sel_hi:[1,0]
    v_pk_mul_f16 v31, v123, v129 op_sel_hi:[1,0]
    v_pk_fma_f16 v152, v120, v128, v28 op_sel:[1,1,0] op_sel_hi:[0,1,1] neg_lo:[1,0,0]
    v_pk_fma_f16 v153, v121, v129, v29 op_sel:[1,1,0] op_sel_hi:[0,1,1] neg_lo:[1,0,0]
    v_pk_fma_f16 v154, v122, v128, v30 op_sel:[1,1,0] op_sel_hi:[0,1,1] neg_lo:[1,0,0]
    v_pk_fma_f16 v155, v123, v129, v31 op_sel:[1,1,0] op_sel_hi:[0,1,1] neg_lo:[1,0,0]
    v_pk_mul_f16 v28, v124, v128 op_sel_hi:[1,0]
    v_pk_mul_f16 v29, v125, v129 op_sel_hi:[1,0]
    v_pk_mul_f16 v30, v126, v128 op_sel_hi:[1,0]
    v_pk_mul_f16 v31, v127, v129 op_sel_hi:[1,0]
    v_pk_fma_f16 v156, v124, v128, v28 op_sel:[1,1,0] op_sel_hi:[0,1,1] neg_lo:[1,0,0]
    v_pk_fma_f16 v157, v125, v129, v29 op_sel:[1,1,0] op_sel_hi:[0,1,1] neg_lo:[1,0,0]
    v_pk_fma_f16 v158, v126, v128, v30 op_sel:[1,1,0] op_sel_hi:[0,1,1] neg_lo:[1,0,0]
    v_pk_fma_f16 v159, v127, v129, v31 op_sel:[1,1,0] op_sel_hi:[0,1,1] neg_lo:[1,0,0]
    s_cmp_eq_u32 s18, 15
    s_cbranch_scc1 KG_b11
    s_barrier
KG_b11:
    s_cmp_eq_u32 s18, 15
    s_cbranch_scc1 KG_b12
    s_barrier
KG_b12:
    s_cmp_eq_u32 s18, 15
    s_cbranch_scc1 KG_b13
    s_barrier
KG_b13:
    s_mov_b32 m0, s21
    s_nop 0
    ds_write_addtid_b32 v32 offset:0
    ds_write_addtid_b32 v34 offset:272
    ds_write_addtid_b32 v36 offset:544
    ds_write_addtid_b32 v38 offset:816
    ds_write_addtid_b32 v40 offset:2176
    ds_write_addtid_b32 v42 offset:2448
    ds_write_addtid_b32 v44 offset:2720
    ds_write_addtid_b32 v46 offset:2992
    ds_write_addtid_b32 v60 offset:4352
    ds_write_addtid_b32 v62 offset:4624
    ds_write_addtid_b32 v64 offset:4896
    ds_write_addtid_b32 v72 offset:5168
    ds_write_addtid_b32 v74 offset:6528
    ds_write_addtid_b32 v76 offset:6800
    ds_write_addtid_b32 v78 offset:7072
    ds_write_addtid_b32 v50 offset:1088
    ds_write_addtid_b32 v50 offset:1360
    ds_write_addtid_b32 v52 offset:1632
    ds_write_addtid_b32 v54 offset:1904
    ds_write_addtid_b32 v54 offset:3264
    ds_write_addtid_b32 v54 offset:3536
    ds_write_addtid_b32 v56 offset:3808
    ds_write_addtid_b32 v58 offset:4080
    ds_write_addtid_b32 v66 offset:5440
    ds_write_addtid_b32 v68 offset:5712
    ds_write_addtid_b32 v70 offset:5984
    ds_write_addtid_b32 v80 offset:6256
    ds_write_addtid_b32 v82 offset:7616
    ds_write_addtid_b32 v84 offset:7888
    ds_write_addtid_b32 v86 offset:8160
    s_mov_b32 m0, s22
    s_nop 0
    ds_write_addtid_b32 v33 offset:16384
    ds_write_addtid_b32 v35 offset:16656
    ds_write_addtid_b32 v37 offset:16928
    ds_write_addtid_b32 v39 offset:17200
    ds_write_addtid_b32 v41 offset:18560
    ds_write_addtid_b32 v43 offset:18832
    ds_write_addtid_b32 v45 offset:19104
    ds_write_addtid_b32 v47 offset:19376
    ds_write_addtid_b32 v61 offset:20736
    ds_write_addtid_b32 v63 offset:21008
    ds_write_addtid_b32 v65 offset:21280
    ds_write_addtid_b32 v73 offset:21552
    ds_write_addtid_b32 v75 offset:22912
    ds_write_addtid_b32 v77 offset:23184
    ds_write_addtid_b32 v79 offset:23456
    ds_write_addtid_b32 v51 offset:17472
    ds_write_addtid_b32 v51 offset:17744
    ds_write_addtid_b32 v53 offset:18016
    ds_write_addtid_b32 v55 offset:18288
    ds_write_addtid_b32 v55 offset:19648
    ds_write_addtid_b32 v55 offset:19920
    ds_write_addtid_b32 v57 offset:20192
    ds_write_addtid_b32 v59 offset:20464
    ds_write_addtid_b32 v67 offset:21824
    ds_write_addtid_b32 v69 offset:22096
    ds_write_addtid_b32 v71 offset:22368
    ds_write_addtid_b32 v81 offset:22640
    ds_write_addtid_b32 v83 offset:24000
    ds_write_addtid_b32 v85 offset:24272
    ds_write_addtid_b32 v87 offset:24544
    ds_read_b128 v[32:35], v4 offset:0
    ds_read_b128 v[36:39], v4 offset:32
    ds_read_b128 v[40:43], v4 offset:64
    ds_read_b128 v[44:47], v4 offset:96
    ds_read_b128 v[48:51], v4 offset:128
    ds_read_b128 v[52:55], v4 offset:160
    ds_read_b128 v[56:59], v4 offset:192
    ds_read_b128 v[60:63], v4 offset:224
    ds_read_b128 v[64:67], v168 offset:16384
    ds_read_b128 v[68:71], v168 offset:16416
    ds_read_b128 v[72:75], v168 offset:16448
    ds_read_b128 v[76:79], v168 offset:16480
    ds_read_b128 v[80:83], v168 offset:16512
    ds_read_b128 v[84:87], v168 offset:16544
    ds_read_b128 v[88:91], v168 offset:16576
    ds_read_b128 v[92:95], v168 offset:16608
    s_mov_b32 m0, s21
    s_nop 0
    ds_write_addtid_b32 v96 offset:0
    ds_write_addtid_b32 v98 offset:272
    ds_write_addtid_b32 v100 offset:544
    ds_write_addtid_b32 v102 offset:816
    ds_write_addtid_b32 v104 offset:1088
    ds_write_addtid_b32 v106 offset:1360
    ds_write_addtid_b32 v108 offset:1632
    ds_write_addtid_b32 v110 offset:1904
    ds_write_addtid_b32 v112 offset:2176
    ds_write_addtid_b32 v114 offset:2448
    ds_write_addtid_b32 v116 offset:2720
    ds_write_addtid_b32 v118 offset:2992
    ds_write_addtid_b32 v120 offset:3264
    ds_write_addtid_b32 v122 offset:3536
    ds_write_addtid_b32 v124 offset:3808
    ds_write_addtid_b32 v126 offset:4080
    ds_write_addtid_b32 v128 offset:4352
    ds_write_addtid_b32 v130 offset:4624
    ds_write_addtid_b32 v132 offset:4896
    ds_write_addtid_b32 v134 offset:5168
    ds_write_addtid_b32 v136 offset:5440
    ds_write_addtid_b32 v138 offset:5712
    ds_write_addtid_b32 v140 offset:5984
    ds_write_addtid_b32 v142 offset:6256
    ds_write_addtid_b32 v144 offset:6528
    ds_write_addtid_b32 v146 offset:6800
    ds_write_addtid_b32 v148 offset:7072
    ds_write_addtid_b32 v150 offset:7344
    ds_write_addtid_b32 v152 offset:7616
    ds_write_addtid_b32 v154 offset:7888
    ds_write_addtid_b32 v156 offset:8160
    ds_write_addtid_b32 v158 offset:8432
    s_mov_b32 m0, s22
    s_nop 0
    ds_write_addtid_b32 v97 offset:16384
    ds_write_addtid_b32 v99 offset:16656
    ds_write_addtid_b32 v101 offset:16928
    ds_write_addtid_b32 v103 offset:17200
    ds_write_addtid_b32 v105 offset:17472
    ds_write_addtid_b32 v107 offset:17744
    ds_write_addtid_b32 v109 offset:18016
    ds_write_addtid_b32 v111 offset:18288
    ds_write_addtid_b32 v113 offset:18560
    ds_write_addtid_b32 v115 offset:18832
    ds_write_addtid_b32 v117 offset:19104
    ds_write_addtid_b32 v119 offset:19376
    ds_write_addtid_b32 v121 offset:19648
    ds_write_addtid_b32 v123 offset:19920
    ds_write_addtid_b32 v125 offset:20192
    ds_write_addtid_b32 v127 offset:20464
    ds_write_addtid_b32 v129 offset:20736
    ds_write_addtid_b32 v131 offset:21008
    ds_write_addtid_b32 v133 offset:21280
    ds_write_addtid_b32 v135 offset:21552
    ds_write_addtid_b32 v137 offset:21824
    ds_write_addtid_b32 v139 offset:22096
    ds_write_addtid_b32 v141 offset:22368
    ds_write_addtid_b32 v143 offset:22640
    ds_write_addtid_b32 v145 offset:22912
    ds_write_addtid_b32 v147 offset:23184
    ds_write_addtid_b32 v149 offset:23456
    ds_write_addtid_b32 v151 offset:23728
    ds_write_addtid_b32 v153 offset:24000
    ds_write_addtid_b32 v155 offset:24272
    ds_write_addtid_b32 v157 offset:24544
    ds_write_addtid_b32 v159 offset:24816
    ds_read_b128 v[96:99], v4 offset:0
    ds_read_b128 v[100:103], v4 offset:32
    ds_read_b128 v[104:107], v4 offset:64
    ds_read_b128 v[108:111], v4 offset:96
    ds_read_b128 v[112:115], v4 offset:128
    ds_read_b128 v[116:119], v4 offset:160
    ds_read_b128 v[120:123], v4 offset:192
    ds_read_b128 v[124:127], v4 offset:224
    ds_read_b128 v[128:131], v168 offset:16384
    ds_read_b128 v[132:135], v168 offset:16416
    ds_read_b128 v[136:139], v168 offset:16448
    ds_read_b128 v[140:143], v168 offset:16480
    ds_read_b128 v[144:147], v168 offset:16512
    ds_read_b128 v[148:151], v168 offset:16544
    ds_read_b128 v[152:155], v168 offset:16576
    ds_read_b128 v[156:159], v168 offset:16608
    s_waitcnt lgkmcnt(15)
    v_mfma_f32_32x32x16_f16 v[8:23], v[32:35], v[96:99], 0
    s_waitcnt lgkmcnt(14)
    v_mfma_f32_32x32x16_f16 v[8:23], v[36:39], v[100:103], v[8:23]
    s_waitcnt lgkmcnt(13)
    v_mfma_f32_32x32x16_f16 v[8:23], v[40:43], v[104:107], v[8:23]
    s_waitcnt lgkmcnt(12)
    v_mfma_f32_32x32x16_f16 v[8:23], v[44:47], v[108:111], v[8:23]
    s_waitcnt lgkmcnt(11)
    v_mfma_f32_32x32x16_f16 v[8:23], v[48:51], v[112:115], v[8:23]
    s_waitcnt lgkmcnt(10)
    v_mfma_f32_32x32x16_f16 v[8:23], v[52:55], v[116:119], v[8:23]
    s_waitcnt lgkmcnt(9)
    v_mfma_f32_32x32x16_f16 v[8:23], v[56:59], v[120:123], v[8:23]
    s_waitcnt lgkmcnt(8)
    v_mfma_f32_32x32x16_f16 v[8:23], v[60:63], v[124:127], v[8:23]
    s_waitcnt lgkmcnt(7)
    v_mfma_f32_32x32x16_f16 v[8:23], v[64:67], v[128:131], v[8:23]
    s_waitcnt lgkmcnt(6)
    v_mfma_f32_32x32x16_f16 v[8:23], v[68:71], v[132:135], v[8:23]
    s_waitcnt lgkmcnt(5)
    v_mfma_f32_32x32x16_f16 v[8:23], v[72:75], v[136:139], v[8:23]
    s_waitcnt lgkmcnt(4)
    v_mfma_f32_32x32x16_f16 v[8:23], v[76:79], v[140:143], v[8:23]
    s_waitcnt lgkmcnt(3)
    v_mfma_f32_32x32x16_f16 v[8:23], v[80:83], v[144:147], v[8:23]
    s_waitcnt lgkmcnt(2)
    v_mfma_f32_32x32x16_f16 v[8:23], v[84:87], v[148:151], v[8:23]
    s_waitcnt lgkmcnt(1)
    v_mfma_f32_32x32x16_f16 v[8:23], v[88:91], v[152:155], v[8:23]
    s_waitcnt lgkmcnt(0)
    v_mfma_f32_32x32x16_f16 v[8:23], v[92:95], v[156:159], v[8:23]
    s_nop 11
    v_fma_f32 v8, v8, v7, v1
    v_mul_f32 v9, v9, v7
    v_mul_f32 v10, v10, v7
    v_mul_f32 v11, v11, v7
    v_mul_f32 v12, v12, v7
    v_mul_f32 v13, v13, v7
    v_mul_f32 v14, v14, v7
    v_mul_f32 v15, v15, v7
    v_cvt_pk_bf16_f32 v32, v8, v9
    v_cvt_pk_bf16_f32 v33, v10, v11
    v_cvt_pk_bf16_f32 v34, v12, v13
    v_cvt_pk_bf16_f32 v35, v14, v15
    buffer_store_dwordx4 v[32:35], v5, s[36:39], s26 offen sc1
    v_mul_f32 v16, v16, v7
    v_mul_f32 v17, v17, v7
    v_mul_f32 v18, v18, v7
    v_mul_f32 v19, v19, v7
    v_mul_f32 v20, v20, v7
    v_mul_f32 v21, v21, v7
    v_mul_f32 v22, v22, v7
    v_cvt_pk_bf16_f32 v36, v16, v17
    v_cvt_pk_bf16_f32 v37, v19, v20
    v_cvt_pk_bf16_f32 v38, v21, v22
    v_cvt_pk_bf16_f32 v39, v18, v18
    buffer_store_dwordx4 v[36:39], v5, s[36:39], s26 offen offset:1024 sc1
    s_cmp_eq_u32 s18, 15
    s_cbranch_scc0 KG_done
    s_add_u32 s26, s26, 10240
    v_mov_b32 v8, v160
    v_mov_b32 v9, v161
    v_mov_b32 v10, v162
    v_mov_b32 v11, v163
    v_mov_b32 v12, v164
    v_mov_b32 v13, v165
    v_mov_b32 v14, v166
    v_mov_b32 v1, v167
    s_add_u32 s17, s17, 16
    s_cmp_lt_u32 s17, 32
    s_cbranch_scc1 KG_round
KG_done:
    s_endpgm
CH_entry:
    s_load_dwordx2 s[54:55], s[0:1], 16
    s_sub_u32 s20, s16, 5
    s_mul_i32 s19, s17, 3
    s_add_u32 s19, s19, s20
    s_mul_i32 s20, s20, 10240
    s_add_u32 s20, s20, 104448
    v_lshlrev_b32 v8, 4, v2
    v_and_b32 v9, 15, v2
    v_lshrrev_b32 v10, 4, v2
    v_mul_u32_u24 v11, 102400, v10
    v_lshl_add_u32 v11, v9, 4, v11
    v_bfe_u32 v12, v2, 2, 2
    v_and_b32 v13, 3, v2
    v_mul_u32_u24 v12, 1280, v12
    v_mul_u32_u24 v10, 160, v10
    v_add3_u32 v12, v12, v10, s20
    v_lshl_add_u32 v14, v13, 4, v12
    v_lshl_add_u32 v15, v13, 3, v12
    s_waitcnt lgkmcnt(0)
    s_mov_b32 s8, s54
    s_mov_b32 s9, s55
    s_mov_b32 s10, 0xc8000
    s_mov_b32 s11, 0x00020000
    s_mov_b32 s36, s34
    s_mov_b32 s37, s35
    s_mov_b32 s38, 0x2000000
    s_mov_b32 s39, 0x00020000
    s_cmp_eq_u32 s16, 5
    s_cbranch_scc0 CH_loop
    s_lshl_b32 s24, s17, 12
    s_mul_i32 s25, s17, 2560
    s_add_u32 s25, s25, 63488
    v_lshl_add_u32 v16, v2, 8, s24
    v_lshl_add_u32 v17, v2, 7, s25
    v_cmp_gt_u32 vcc, 16, v2
    v_mov_b32 v18, 0
    v_mov_b32 v19, 0
    s_mov_b32 s24, 28311552
    v_cndmask_b32 v16, v17, v16, vcc
    s_mov_b32 exec_hi, 0x0000000f
    buffer_store_dwordx2 v[18:19], v16, s[36:39], s24 offen sc1
    s_mov_b32 exec_hi, -1
CH_loop:
    s_lshr_b32 s24, s19, 2
    s_bfe_u32 s25, s19, 0x10001
    s_add_u32 s25, s25, s24
    s_add_u32 s25, s25, s19
    s_mul_i32 s26, s19, 5
    s_sub_u32 s26, s26, 318
    s_cmp_lt_u32 s19, 64
    s_cselect_b32 s26, s25, s26
    s_mul_i32 s26, s26, 10240
    s_mul_i32 s24, s24, 5120
    s_and_b32 s25, s19, 3
    s_lshl_b32 s25, s25, 8
    s_add_u32 s24, s24, s25
    s_add_u32 s24, s24, 13631488
    s_add_u32 m0, s20, 0
    s_add_u32 s27, s26, 0
    buffer_load_dwordx4 v8, s[8:11], s27 offen offset:0 lds
    buffer_load_dwordx4 v8, s[8:11], s27 offen offset:1024 lds
    buffer_load_dwordx4 v8, s[8:11], s27 offen offset:2048 lds
    buffer_load_dwordx4 v8, s[8:11], s27 offen offset:3072 lds
    s_add_u32 m0, s20, 4096
    s_add_u32 s27, s26, 4096
    buffer_load_dwordx4 v8, s[8:11], s27 offen offset:0 lds
    buffer_load_dwordx4 v8, s[8:11], s27 offen offset:1024 lds
    buffer_load_dwordx4 v8, s[8:11], s27 offen offset:2048 lds
    buffer_load_dwordx4 v8, s[8:11], s27 offen offset:3072 lds
    s_add_u32 m0, s20, 8192
    s_add_u32 s27, s26, 8192
    buffer_load_dwordx4 v8, s[8:11], s27 offen offset:0 lds
    buffer_load_dwordx4 v8, s[8:11], s27 offen offset:1024 lds
    s_waitcnt vmcnt(0)
    ds_read_b64_tr_b16 v[16:17], v14 offset:0
    ds_read_b64_tr_b16 v[18:19], v14 offset:5120
    ds_read_b64_tr_b16 v[20:21], v14 offset:8
    ds_read_b64_tr_b16 v[22:23], v14 offset:5128
    ds_read_b64_tr_b16 v[24:25], v14 offset:64
    ds_read_b64_tr_b16 v[26:27], v14 offset:5184
    ds_read_b64_tr_b16 v[28:29], v14 offset:72
    ds_read_b64_tr_b16 v[30:31], v14 offset:5192
    ds_read_b64_tr_b16 v[32:33], v15 offset:128
    ds_read_b64_tr_b16 v[34:35], v15 offset:5248
    ds_read_b64_tr_b16 v[36:37], v14 offset:640
    ds_read_b64_tr_b16 v[38:39], v14 offset:5760
    ds_read_b64_tr_b16 v[40:41], v14 offset:648
    ds_read_b64_tr_b16 v[42:43], v14 offset:5768
    ds_read_b64_tr_b16 v[44:45], v14 offset:704
    ds_read_b64_tr_b16 v[46:47], v14 offset:5824
    ds_read_b64_tr_b16 v[48:49], v14 offset:712
    ds_read_b64_tr_b16 v[50:51], v14 offset:5832
    ds_read_b64_tr_b16 v[52:53], v15 offset:768
    ds_read_b64_tr_b16 v[54:55], v15 offset:5888
    s_waitcnt lgkmcnt(0)
    s_add_u32 s25, s24, 0
    buffer_store_dwordx4 v[16:19], v11, s[36:39], s25 offen sc1
    s_add_u32 s25, s24, 1024
    buffer_store_dwordx4 v[20:23], v11, s[36:39], s25 offen sc1
    s_add_u32 s25, s24, 2048
    buffer_store_dwordx4 v[24:27], v11, s[36:39], s25 offen sc1
    s_add_u32 s25, s24, 3072
    buffer_store_dwordx4 v[28:31], v11, s[36:39], s25 offen sc1
    s_add_u32 s25, s24, 4096
    buffer_store_dwordx4 v[32:35], v11, s[36:39], s25 offen sc1
    s_add_u32 s25, s24, 409600
    buffer_store_dwordx4 v[36:39], v11, s[36:39], s25 offen sc1
    s_add_u32 s25, s24, 410624
    buffer_store_dwordx4 v[40:43], v11, s[36:39], s25 offen sc1
    s_add_u32 s25, s24, 411648
    buffer_store_dwordx4 v[44:47], v11, s[36:39], s25 offen sc1
    s_add_u32 s25, s24, 412672
    buffer_store_dwordx4 v[48:51], v11, s[36:39], s25 offen sc1
    s_add_u32 s25, s24, 413696
    buffer_store_dwordx4 v[52:55], v11, s[36:39], s25 offen sc1
    s_add_u32 s19, s19, 48
    s_cmp_lt_u32 s19, 80
    s_cbranch_scc1 CH_loop
    s_endpgm
.globl k2_kernel
.p2align 8
.type k2_kernel,@function
k2_kernel:
    s_load_dwordx2 s[4:5], s[0:1], 112
    s_cmp_ge_u32 s2, 256
    s_cbranch_scc1 C_entry
A_entry:
    v_lshrrev_b32 v1, 6, v0
    v_and_b32 v2, 63, v0
    s_and_b32 s3, s2, 7
    v_readfirstlane_b32 s16, v1
    s_lshr_b32 s25, s2, 3
    s_and_b32 s26, s25, 3
    s_lshl_b32 s17, s3, 2
    s_add_u32 s17, s17, s26
    s_lshr_b32 s18, s25, 2
    v_lshrrev_b32 v3, 5, v2
    v_and_b32 v120, 31, v2
    v_lshlrev_b32 v99, 4, v2
    v_lshlrev_b32 v4, 4, v120
    v_lshl_add_u32 v119, v3, 9, v4
    v_lshl_add_u32 v5, v3, 3, v4
    s_lshr_b32 s30, s16, 2
    s_mul_i32 s19, s16, 123008
    s_mul_i32 s20, s16, 3072
    s_lshr_b32 s34, s17, 1
    s_mul_i32 s34, s34, 5
    s_and_b32 s35, s17, 1
    s_mul_i32 s36, s35, 3
    s_add_u32 s36, s36, s34
    s_lshl_b32 s37, s36, 9
    s_lshl_b32 s36, s36, 3
    s_mul_i32 s35, s35, -20
    s_add_u32 s35, s35, 8
    s_lshl_b32 s34, s34, 9
    s_add_u32 s38, s37, 40960
    v_add_u32 v121, s38, v99
    s_add_u32 s38, s34, 40960
    v_add_u32 v6, s38, v4
    s_lshl_b32 s25, s18, 3
    s_and_b32 s26, s16, 3
    s_lshl_b32 s26, s26, 1
    s_add_u32 s25, s25, s26
    s_add_u32 s29, s25, s30
    s_mul_i32 s29, s29, 40960
    s_mul_i32 s25, s25, 123008
    s_add_u32 s37, s37, s25
    s_add_u32 s34, s34, s25
    s_add_u32 s40, s37, 123008
    s_add_u32 s41, s34, 123008
    s_mov_b32 s22, 0
    s_mov_b32 s31, 0x3eb00000
    s_movk_i32 s39, 96
    v_add_u32 v8, 32, v2
    s_mov_b32 m0, s20
    v_mul_u32_u24 v16, 43, v120
    v_mul_u32_u24 v20, 43, v8
    v_lshrrev_b32 v16, 10, v16
    v_lshrrev_b32 v20, 10, v20
    v_mul_u32_u24 v17, 24, v16
    v_mul_u32_u24 v21, 24, v20
    v_sub_u32 v17, v120, v17
    v_sub_u32 v21, v8, v21
    v_and_b32 v18, 3, v17
    v_and_b32 v22, 3, v21
    v_bfe_u32 v19, v17, 2, 1
    v_bfe_u32 v23, v21, 2, 1
    v_lshl_add_u32 v18, v19, 3, v18
    v_lshl_add_u32 v22, v23, 3, v22
    v_lshrrev_b32 v19, 3, v17
    v_lshrrev_b32 v23, 3, v21
    v_lshl_add_u32 v18, v19, 2, v18
    v_lshl_add_u32 v22, v23, 2, v22
    v_lshrrev_b32 v19, 4, v17
    v_lshrrev_b32 v23, 4, v21
    v_mad_i32_i24 v18, v19, s35, v18
    v_mad_i32_i24 v22, v23, s35, v22
    v_add_u32 v18, s36, v18
    v_add_u32 v22, s36, v22
    v_lshrrev_b32 v19, 5, v18
    v_lshrrev_b32 v23, 5, v22
    v_lshl_add_u32 v18, v16, 5, v18
    v_lshl_add_u32 v22, v20, 5, v22
    v_mad_u32_u24 v18, v19, s39, v18
    v_mad_u32_u24 v22, v23, s39, v22
    v_add_u32 v19, 2540, v17
    v_add_u32 v23, 2540, v21
    v_cmp_gt_u32 s[42:43], 20, v17
    v_cmp_gt_u32 s[44:45], 20, v21
    v_mov_b32 v16, 80896
    v_mov_b32 v20, 79872
    v_cndmask_b32 v18, v19, v18, s[42:43]
    v_cndmask_b32 v22, v23, v22, s[44:45]
    v_lshl_add_u32 v122, v18, 4, v16
    v_lshl_add_u32 v123, v22, 4, v20
    v_cmp_eq_u32 vcc, 0, v3
    s_nop 1
    v_cndmask_b32 v122, v122, v6, vcc
    s_waitcnt lgkmcnt(0)
    s_mov_b32 s8, s4
    s_mov_b32 s9, s5
    s_mov_b32 s10, 0x2000000
    s_mov_b32 s11, 0x00020000
    buffer_load_dwordx4 v121, s[8:11], s19 offen offset:0 lds
    buffer_load_dwordx4 v122, s[8:11], s19 offen offset:1024 lds
    buffer_load_dwordx4 v123, s[8:11], s19 offen offset:2048 lds
    buffer_load_dwordx4 v[80:83], v119, s[8:11], s37 offen
    buffer_load_dwordx2 v[88:89], v5, s[8:11], s34 offen offset:1024
    buffer_load_dwordx4 v[84:87], v119, s[8:11], s40 offen
    buffer_load_dwordx2 v[90:91], v5, s[8:11], s41 offen offset:1024
    s_add_u32 m0, s20, 24576
    s_add_u32 s24, s19, 984064
    buffer_load_dwordx4 v121, s[8:11], s24 offen offset:0 lds
    buffer_load_dwordx4 v122, s[8:11], s24 offen offset:1024 lds
    buffer_load_dwordx4 v123, s[8:11], s24 offen offset:2048 lds
    s_and_b32 s25, s17, 1
    v_cmp_eq_u32 s[32:33], s25, v3
    v_mov_b32 v6, 832
    v_mul_u32_u24 v118, 384, v3
    v_min_u32 v4, 368, v4
    v_add_u32 v118, v118, v4
    v_cndmask_b32 v5, v6, v5, s[32:33]
    s_mul_i32 s25, s30, 3072
    v_mov_b32 v98, 0xdddddddd
    v_add_u32 v116, s25, v119
    v_add_u32 v117, s25, v5
    v_add_u32 v118, s25, v118
    v_mov_b32 v18, v5
    s_branch A_started
A_start:
    s_mov_b32 m0, s20
    s_add_u32 s24, s19, 984064
    buffer_load_dwordx4 v121, s[8:11], s19 offen offset:0 lds
    buffer_load_dwordx4 v122, s[8:11], s19 offen offset:1024 lds
    buffer_load_dwordx4 v123, s[8:11], s19 offen offset:2048 lds
    s_add_u32 m0, s20, 24576
    s_nop 0
    buffer_load_dwordx4 v121, s[8:11], s24 offen offset:0 lds
    buffer_load_dwordx4 v122, s[8:11], s24 offen offset:1024 lds
    buffer_load_dwordx4 v123, s[8:11], s24 offen offset:2048 lds
A_started:
    s_add_u32 s24, s19, 1968128
    v_mov_b32 v4, 0
    v_mov_b32 v5, 73984
    ds_write_b32 v5, v4
    v_mov_b32 v48, 0
    v_mov_b32 v49, 0
    v_mov_b32 v50, 0
    v_mov_b32 v51, 0
    v_mov_b32 v52, 0
    v_mov_b32 v53, 0
    v_mov_b32 v54, 0
    v_mov_b32 v55, 0
    v_mov_b32 v56, 0
    v_mov_b32 v57, 0
    v_mov_b32 v58, 0
    v_mov_b32 v59, 0
    v_mov_b32 v60, 0
    v_mov_b32 v61, 0
    v_mov_b32 v62, 0
    v_mov_b32 v63, 0
    v_mov_b32 v64, 0
    v_mov_b32 v65, 0
    v_mov_b32 v66, 0
    v_mov_b32 v67, 0
    v_mov_b32 v68, 0
    v_mov_b32 v69, 0
    v_mov_b32 v70, 0
    v_mov_b32 v71, 0
    v_mov_b32 v72, 0
    v_mov_b32 v73, 0
    v_mov_b32 v74, 0
    v_mov_b32 v75, 0
    v_mov_b32 v76, 0
    v_mov_b32 v77, 0
    v_mov_b32 v78, 0
    v_mov_b32 v79, 0
    v_mov_b32 v108, 0
    v_mov_b32 v109, 0
    v_mov_b32 v110, 0
    v_mov_b32 v111, 0
    v_mov_b32 v112, v116
    v_mov_b32 v113, v117
    v_mov_b32 v114, v118
    v_mov_b32 v115, v118
    s_mov_b32 s21, 0
    s_mov_b32 s23, 24576
    s_waitcnt vmcnt(3) lgkmcnt(0)
    s_barrier
    s_cmp_lg_u32 s22, 0
    s_cbranch_scc1 A_havemax
    ds_read_b128 v[4:7], v119
    ds_read_b64 v[8:9], v18 offset:1024
    ds_read_b128 v[92:95], v112
    ds_read_b64 v[96:97], v113 offset:1024
    ds_read_b128 v[100:103], v114 offset:1536
    v_cndmask_b32 v88, 0, v88, s[32:33]
    v_cndmask_b32 v89, 0, v89, s[32:33]
    v_cndmask_b32 v90, 0, v90, s[32:33]
    v_cndmask_b32 v91, 0, v91, s[32:33]
    s_waitcnt lgkmcnt(3)
    v_mfma_f32_32x32x16_bf16 v[16:31], v[4:7], v[80:83], 0
    v_mfma_f32_32x32x8_bf16 v[16:31], v[8:9], v[88:89], v[16:31]
    v_mfma_f32_32x32x16_bf16 v[32:47], v[4:7], v[84:87], 0
    v_mfma_f32_32x32x8_bf16 v[32:47], v[8:9], v[90:91], v[32:47]
    s_nop 9
    v_max3_f32 v10, v16, v17, v18
    v_max3_f32 v11, v19, v20, v21
    v_max3_f32 v10, v10, v22, v23
    v_max3_f32 v11, v11, v24, v25
    v_max3_f32 v10, v10, v26, v27
    v_max3_f32 v11, v11, v28, v29
    v_max3_f32 v10, v10, v30, v31
    v_max_f32 v10, v10, v11
    v_mov_b32 v11, v10
    s_nop 1
    v_permlane32_swap_b32 v10, v11
    v_max_f32 v10, v10, v11
    v_and_b32 v11, 0xffff0000, v10
    v_sub_f32 v10, v11, v10
    v_cvt_pk_bf16_f32 v10, -v11, v10
    v_cndmask_b32 v88, v10, v88, s[32:33]
    s_waitcnt lgkmcnt(1)
    v_mfma_f32_32x32x16_bf16 v[16:31], v[92:95], v[80:83], 0
    v_mfma_f32_32x32x8_bf16 v[16:31], v[96:97], v[88:89], v[16:31]
    v_max3_f32 v12, v32, v33, v34
    v_max3_f32 v13, v35, v36, v37
    v_max3_f32 v12, v12, v38, v39
    v_max3_f32 v13, v13, v40, v41
    v_max3_f32 v12, v12, v42, v43
    v_max3_f32 v13, v13, v44, v45
    v_max3_f32 v12, v12, v46, v47
    v_max_f32 v12, v12, v13
    v_mov_b32 v13, v12
    s_nop 1
    v_permlane32_swap_b32 v12, v13
    v_max_f32 v12, v12, v13
    v_and_b32 v13, 0xffff0000, v12
    v_sub_f32 v12, v13, v12
    v_cvt_pk_bf16_f32 v12, -v13, v12
    v_cndmask_b32 v90, v12, v90, s[32:33]
    s_branch A_preloop
A_havemax:
    ds_read_b128 v[92:95], v112
    ds_read_b64 v[96:97], v113 offset:1024
    ds_read_b128 v[100:103], v114 offset:1536
    s_waitcnt lgkmcnt(1)
    v_mfma_f32_32x32x16_bf16 v[16:31], v[92:95], v[80:83], 0
    v_mfma_f32_32x32x8_bf16 v[16:31], v[96:97], v[88:89], v[16:31]
    s_nop 7
A_preloop:
    s_waitcnt lgkmcnt(0)
A_loop:
    ds_read_b128 v[104:107], v114 offset:7680
    s_setprio 2
    v_smfmac_f32_32x32x32_bf16 v[64:79], v[108:111], v[40:47], v98
    ds_read_b128 v[108:111], v115 offset:2304
    v_exp_f32 v16, v16
    v_exp_f32 v17, v17
    v_exp_f32 v18, v18
    v_exp_f32 v19, v19
    v_mfma_f32_32x32x16_bf16 v[32:47], v[92:95], v[84:87], 0
    ds_read_b128 v[92:95], v112 offset:6144
    v_exp_f32 v20, v20
    v_exp_f32 v21, v21
    v_exp_f32 v22, v22
    v_exp_f32 v23, v23
    v_mfma_f32_32x32x8_bf16 v[32:47], v[96:97], v[90:91], v[32:47]
    ds_read_b64 v[96:97], v113 offset:7168
    v_exp_f32 v24, v24
    v_exp_f32 v25, v25
    v_exp_f32 v26, v26
    v_exp_f32 v27, v27
    v_smfmac_f32_32x32x32_bf16 v[48:63], v[100:103], v[16:23], v98
    v_exp_f32 v28, v28
    v_exp_f32 v29, v29
    v_exp_f32 v30, v30
    v_exp_f32 v31, v31
    s_nop 0
    s_waitcnt lgkmcnt(0)
    v_smfmac_f32_32x32x32_bf16 v[48:63], v[108:111], v[24:31], v98
    v_exp_f32 v32, v32
    v_exp_f32 v33, v33
    v_exp_f32 v34, v34
    v_exp_f32 v35, v35
    v_mfma_f32_32x32x16_bf16 v[16:31], v[92:95], v[80:83], 0
    v_exp_f32 v36, v36
    v_exp_f32 v37, v37
    v_exp_f32 v38, v38
    v_exp_f32 v39, v39
    v_mfma_f32_32x32x8_bf16 v[16:31], v[96:97], v[88:89], v[16:31]
    v_exp_f32 v40, v40
    v_exp_f32 v41, v41
    v_exp_f32 v42, v42
    v_exp_f32 v43, v43
    v_smfmac_f32_32x32x32_bf16 v[64:79], v[100:103], v[32:39], v98
    v_exp_f32 v44, v44
    v_exp_f32 v45, v45
    v_exp_f32 v46, v46
    v_exp_f32 v47, v47
    ds_read_b128 v[100:103], v114 offset:13824
    s_setprio 1
    v_smfmac_f32_32x32x32_bf16 v[64:79], v[108:111], v[40:47], v98
    ds_read_b128 v[108:111], v115 offset:8448
    v_exp_f32 v16, v16
    v_exp_f32 v17, v17
    v_exp_f32 v18, v18
    v_exp_f32 v19, v19
    v_mfma_f32_32x32x16_bf16 v[32:47], v[92:95], v[84:87], 0
    ds_read_b128 v[92:95], v112 offset:12288
    v_exp_f32 v20, v20
    v_exp_f32 v21, v21
    v_exp_f32 v22, v22
    v_exp_f32 v23, v23
    v_mfma_f32_32x32x8_bf16 v[32:47], v[96:97], v[90:91], v[32:47]
    ds_read_b64 v[96:97], v113 offset:13312
    v_exp_f32 v24, v24
    v_exp_f32 v25, v25
    v_exp_f32 v26, v26
    v_exp_f32 v27, v27
    v_smfmac_f32_32x32x32_bf16 v[48:63], v[104:107], v[16:23], v98
    v_exp_f32 v28, v28
    v_exp_f32 v29, v29
    v_exp_f32 v30, v30
    v_exp_f32 v31, v31
    s_nop 0
    s_waitcnt lgkmcnt(0)
    v_smfmac_f32_32x32x32_bf16 v[48:63], v[108:111], v[24:31], v98
    v_exp_f32 v32, v32
    v_exp_f32 v33, v33
    v_exp_f32 v34, v34
    v_exp_f32 v35, v35
    v_mfma_f32_32x32x16_bf16 v[16:31], v[92:95], v[80:83], 0
    v_exp_f32 v36, v36
    v_exp_f32 v37, v37
    v_exp_f32 v38, v38
    v_exp_f32 v39, v39
    v_mfma_f32_32x32x8_bf16 v[16:31], v[96:97], v[88:89], v[16:31]
    v_exp_f32 v40, v40
    v_exp_f32 v41, v41
    v_exp_f32 v42, v42
    v_exp_f32 v43, v43
    v_smfmac_f32_32x32x32_bf16 v[64:79], v[104:107], v[32:39], v98
    v_exp_f32 v44, v44
    v_exp_f32 v45, v45
    v_exp_f32 v46, v46
    v_exp_f32 v47, v47
    ds_read_b128 v[104:107], v114 offset:19968
    s_setprio 0
    v_smfmac_f32_32x32x32_bf16 v[64:79], v[108:111], v[40:47], v98
    ds_read_b128 v[108:111], v115 offset:14592
    v_exp_f32 v16, v16
    v_exp_f32 v17, v17
    v_exp_f32 v18, v18
    v_exp_f32 v19, v19
    v_mfma_f32_32x32x16_bf16 v[32:47], v[92:95], v[84:87], 0
    ds_read_b128 v[92:95], v112 offset:18432
    v_exp_f32 v20, v20
    v_exp_f32 v21, v21
    v_exp_f32 v22, v22
    v_exp_f32 v23, v23
    v_mfma_f32_32x32x8_bf16 v[32:47], v[96:97], v[90:91], v[32:47]
    ds_read_b64 v[96:97], v113 offset:19456
    v_exp_f32 v24, v24
    v_exp_f32 v25, v25
    v_exp_f32 v26, v26
    v_exp_f32 v27, v27
    v_smfmac_f32_32x32x32_bf16 v[48:63], v[100:103], v[16:23], v98
    v_exp_f32 v28, v28
    v_exp_f32 v29, v29
    v_exp_f32 v30, v30
    v_exp_f32 v31, v31
    s_nop 0
    s_waitcnt lgkmcnt(0)
    v_smfmac_f32_32x32x32_bf16 v[48:63], v[108:111], v[24:31], v98
    v_exp_f32 v32, v32
    v_exp_f32 v33, v33
    v_exp_f32 v34, v34
    v_exp_f32 v35, v35
    v_mfma_f32_32x32x16_bf16 v[16:31], v[92:95], v[80:83], 0
    v_exp_f32 v36, v36
    v_exp_f32 v37, v37
    v_exp_f32 v38, v38
    v_exp_f32 v39, v39
    v_mfma_f32_32x32x8_bf16 v[16:31], v[96:97], v[88:89], v[16:31]
    v_exp_f32 v40, v40
    v_exp_f32 v41, v41
    v_exp_f32 v42, v42
    v_exp_f32 v43, v43
    v_smfmac_f32_32x32x32_bf16 v[64:79], v[100:103], v[32:39], v98
    v_exp_f32 v44, v44
    v_exp_f32 v45, v45
    v_exp_f32 v46, v46
    v_exp_f32 v47, v47
    s_cmp_eq_u32 s21, 7
    s_cbranch_scc1 A_nobar
    s_waitcnt vmcnt(0)
    s_barrier
    v_add_u32 v112, s23, v116
    v_add_u32 v113, s23, v117
    v_add_u32 v114, s23, v118
    s_cmp_eq_u32 s21, 6
    s_cbranch_scc1 A_nobar
    s_add_u32 s25, s23, 24576
    s_cmp_eq_u32 s25, 73728
    s_cselect_b32 s25, 0, s25
    s_add_u32 m0, s20, s25
    s_nop 0
    buffer_load_dwordx4 v121, s[8:11], s24 offen offset:0 lds
    buffer_load_dwordx4 v122, s[8:11], s24 offen offset:1024 lds
    buffer_load_dwordx4 v123, s[8:11], s24 offen offset:2048 lds
    s_add_u32 s24, s24, 984064
A_nobar:
    ds_read_b128 v[100:103], v114 offset:1536
    s_setprio 3
    v_smfmac_f32_32x32x32_bf16 v[64:79], v[108:111], v[40:47], v98
    ds_read_b128 v[108:111], v115 offset:20736
    v_exp_f32 v16, v16
    v_exp_f32 v17, v17
    v_exp_f32 v18, v18
    v_exp_f32 v19, v19
    v_mfma_f32_32x32x16_bf16 v[32:47], v[92:95], v[84:87], 0
    ds_read_b128 v[92:95], v112 offset:0
    v_exp_f32 v20, v20
    v_exp_f32 v21, v21
    v_exp_f32 v22, v22
    v_exp_f32 v23, v23
    v_mfma_f32_32x32x8_bf16 v[32:47], v[96:97], v[90:91], v[32:47]
    ds_read_b64 v[96:97], v113 offset:1024
    v_exp_f32 v24, v24
    v_exp_f32 v25, v25
    v_exp_f32 v26, v26
    v_exp_f32 v27, v27
    v_smfmac_f32_32x32x32_bf16 v[48:63], v[104:107], v[16:23], v98
    v_exp_f32 v28, v28
    v_exp_f32 v29, v29
    v_exp_f32 v30, v30
    v_exp_f32 v31, v31
    s_nop 0
    s_waitcnt lgkmcnt(0)
    v_smfmac_f32_32x32x32_bf16 v[48:63], v[108:111], v[24:31], v98
    v_exp_f32 v32, v32
    v_exp_f32 v33, v33
    v_exp_f32 v34, v34
    v_exp_f32 v35, v35
    v_mfma_f32_32x32x16_bf16 v[16:31], v[92:95], v[80:83], 0
    v_exp_f32 v36, v36
    v_exp_f32 v37, v37
    v_exp_f32 v38, v38
    v_exp_f32 v39, v39
    v_mfma_f32_32x32x8_bf16 v[16:31], v[96:97], v[88:89], v[16:31]
    v_exp_f32 v40, v40
    v_exp_f32 v41, v41
    v_exp_f32 v42, v42
    v_exp_f32 v43, v43
    v_smfmac_f32_32x32x32_bf16 v[64:79], v[104:107], v[32:39], v98
    v_mov_b32 v115, v114
    v_exp_f32 v44, v44
    v_exp_f32 v45, v45
    v_exp_f32 v46, v46
    v_exp_f32 v47, v47
    s_add_u32 s23, s23, 24576
    s_cmp_eq_u32 s23, 73728
    s_cselect_b32 s23, 0, s23
    s_add_u32 s21, s21, 1
    s_cmp_lg_u32 s21, 8
    s_cbranch_scc1 A_loop
    v_smfmac_f32_32x32x32_bf16 v[64:79], v[108:111], v[40:47], v98
    s_lshl_b32 s25, s17, 8
    s_lshl_b32 s27, s17, 10
    s_add_u32 s26, s29, 10485760
    s_add_u32 s27, s27, s26
    s_add_u32 s25, s25, s26
    s_add_u32 s25, s25, 32768
    v_lshrrev_b32 v112, 1, v119
    s_xor_b32 s26, s16, 4
    s_mul_i32 s26, s26, 3072
    v_add_u32 v4, s20, v99
    v_add_u32 v5, s26, v99
    v_mov_b32 v6, 73984
    v_max_f32 v7, v56, v72
    v_add_f32 v8, v56, v72
    v_cmp_ngt_f32 vcc, 0x5f000000, v8
    s_cmp_lg_u32 s30, 0
    s_cbranch_scc1 A_x1
    ds_write_b128 v4, v[64:67] offset:49152
    ds_write_b128 v4, v[68:71] offset:50176
    ds_write_b128 v4, v[72:75] offset:51200
    s_branch A_x2
A_x1:
    ds_write_b128 v4, v[48:51] offset:49152
    ds_write_b128 v4, v[52:55] offset:50176
    ds_write_b128 v4, v[56:59] offset:51200
    v_mov_b32 v48, v64
    v_mov_b32 v49, v65
    v_mov_b32 v50, v66
    v_mov_b32 v51, v67
    v_mov_b32 v52, v68
    v_mov_b32 v53, v69
    v_mov_b32 v54, v70
    v_mov_b32 v55, v71
    v_mov_b32 v56, v72
    v_mov_b32 v57, v73
    v_mov_b32 v58, v74
    v_mov_b32 v59, v75
A_x2:
    s_cmp_eq_u32 vcc_hi, 0
    s_cbranch_scc1 A_ok
    ds_write_b32 v6, v98
A_ok:
    s_waitcnt lgkmcnt(0)
    s_barrier
    ds_read_b128 v[24:27], v5 offset:51200
    ds_read_b128 v[16:19], v5 offset:49152
    ds_read_b128 v[20:23], v5 offset:50176
    ds_read_b32 v7, v6
    s_waitcnt lgkmcnt(3)
    v_add_f32 v56, v56, v24
    v_add_f32 v57, v57, v25
    v_add_f32 v58, v58, v26
    v_add_f32 v59, v59, v27
    v_mov_b32 v4, v56
    v_mov_b32 v5, v56
    s_nop 1
    v_permlane32_swap_b32 v4, v5
    v_rcp_f32 v4, v5
    s_waitcnt lgkmcnt(1)
    v_add_f32 v48, v48, v16
    v_add_f32 v49, v49, v17
    v_add_f32 v50, v50, v18
    v_add_f32 v51, v51, v19
    v_add_f32 v52, v52, v20
    v_add_f32 v53, v53, v21
    v_add_f32 v54, v54, v22
    v_add_f32 v55, v55, v23
    v_mul_f32 v48, v48, v4
    v_mul_f32 v49, v49, v4
    v_mul_f32 v50, v50, v4
    v_mul_f32 v51, v51, v4
    v_mul_f32 v52, v52, v4
    v_mul_f32 v53, v53, v4
    v_mul_f32 v54, v54, v4
    v_mul_f32 v55, v55, v4
    v_mul_f32 v56, v56, v4
    v_mul_f32 v57, v57, v4
    v_mul_f32 v58, v58, v4
    v_mul_f32 v59, v59, v4
    v_cvt_pk_bf16_f32 v8, v48, v49
    v_cvt_pk_bf16_f32 v9, v50, v51
    v_cvt_pk_bf16_f32 v10, v52, v53
    v_cvt_pk_bf16_f32 v11, v54, v55
    v_cvt_pk_bf16_f32 v12, v56, v57
    v_cvt_pk_bf16_f32 v13, v58, v59
    buffer_store_dwordx4 v[8:11], v119, s[8:11], s27 offen sc1
    v_mov_b32_dpp v14, v12 quad_perm:[1,1,3,3] row_mask:0xf bank_mask:0xf
    v_mov_b32_dpp v15, v13 quad_perm:[1,1,3,3] row_mask:0xf bank_mask:0xf
    s_mov_b64 exec, 0x55555555
    buffer_store_dwordx4 v[12:15], v112, s[8:11], s25 offen sc1
    s_mov_b64 exec, -1
    s_waitcnt lgkmcnt(0)
    v_readfirstlane_b32 s25, v7
    s_cmp_lg_u32 s22, 0
    s_cbranch_scc1 A_end
    s_cmp_eq_u32 s25, 0
    s_cbranch_scc1 A_end
    s_waitcnt vmcnt(0)
    v_mov_b32 v10, 0xff800000
    v_mov_b32 v12, 0xff800000
    v_cndmask_b32 v88, 0, v88, s[32:33]
    v_cndmask_b32 v90, 0, v90, s[32:33]
    s_mov_b32 s21, 0
    s_mov_b32 s24, s19
    s_mov_b32 m0, s20
    s_mul_i32 s26, s30, 3072
A_fchunk:
    s_barrier
    buffer_load_dwordx4 v121, s[8:11], s24 offen offset:0 lds
    buffer_load_dwordx4 v122, s[8:11], s24 offen offset:1024 lds
    buffer_load_dwordx4 v123, s[8:11], s24 offen offset:2048 lds
    s_add_u32 s24, s24, 984064
    v_subrev_u32 v112, s26, v116
    v_subrev_u32 v113, s26, v117
    s_mov_b32 s25, 0
    s_waitcnt vmcnt(0)
    s_barrier
A_ftile:
    ds_read_b128 v[92:95], v112
    ds_read_b64 v[96:97], v113 offset:1024
    v_add_u32 v112, 3072, v112
    v_add_u32 v113, 3072, v113
    s_waitcnt lgkmcnt(0)
    v_mfma_f32_32x32x16_bf16 v[16:31], v[92:95], v[80:83], 0
    v_mfma_f32_32x32x8_bf16 v[16:31], v[96:97], v[88:89], v[16:31]
    v_mfma_f32_32x32x16_bf16 v[32:47], v[92:95], v[84:87], 0
    v_mfma_f32_32x32x8_bf16 v[32:47], v[96:97], v[90:91], v[32:47]
    s_nop 9
    v_max3_f32 v10, v10, v16, v17
    v_max3_f32 v10, v10, v18, v19
    v_max3_f32 v10, v10, v20, v21
    v_max3_f32 v10, v10, v22, v23
    v_max3_f32 v10, v10, v24, v25
    v_max3_f32 v10, v10, v26, v27
    v_max3_f32 v10, v10, v28, v29
    v_max3_f32 v10, v10, v30, v31
    v_max3_f32 v12, v12, v32, v33
    v_max3_f32 v12, v12, v34, v35
    v_max3_f32 v12, v12, v36, v37
    v_max3_f32 v12, v12, v38, v39
    v_max3_f32 v12, v12, v40, v41
    v_max3_f32 v12, v12, v42, v43
    v_max3_f32 v12, v12, v44, v45
    v_max3_f32 v12, v12, v46, v47
    s_add_u32 s25, s25, 1
    s_cmp_lg_u32 s25, 8
    s_cbranch_scc1 A_ftile
    s_add_u32 s21, s21, 1
    s_cmp_lg_u32 s21, 8
    s_cbranch_scc1 A_fchunk
    v_mov_b32 v11, v10
    s_nop 1
    v_permlane32_swap_b32 v10, v11
    v_max_f32 v10, v10, v11
    v_and_b32 v11, 0xffff0000, v10
    v_sub_f32 v10, v11, v10
    v_cvt_pk_bf16_f32 v10, -v11, v10
    v_cndmask_b32 v88, v10, v88, s[32:33]
    v_mov_b32 v13, v12
    s_nop 1
    v_permlane32_swap_b32 v12, v13
    v_max_f32 v12, v12, v13
    v_and_b32 v13, 0xffff0000, v12
    v_sub_f32 v12, v13, v12
    v_cvt_pk_bf16_f32 v12, -v13, v12
    v_cndmask_b32 v90, v12, v90, s[32:33]
    s_mov_b32 s22, 1
    s_barrier
    s_branch A_start
A_end:
    s_lshl_b32 s25, s18, 5
    s_add_u32 s25, s25, s17
    s_lshl_b32 s25, s25, 8
    s_add_u32 s25, s25, 28311552
    s_cmp_lg_u32 s16, 0
    s_waitcnt vmcnt(0)
    s_barrier
    s_cbranch_scc1 A_nf
    s_mov_b64 exec, 1
    buffer_store_dword v98, off, s[8:11], s25 sc1
    s_mov_b64 exec, -1
A_nf:
A_exit:
    s_endpgm
C_entry:
    s_cmp_ge_u32 s2, 512
    s_cbranch_scc1 C_exit
    s_load_dwordx2 s[12:13], s[0:1], 96
    s_setprio 0
    v_lshrrev_b32 v1, 6, v0
    v_and_b32 v2, 63, v0
    s_sub_u32 s18, s2, 256
    v_readfirstlane_b32 s16, v1
    s_and_b32 s17, s18, 7
    s_mul_i32 s17, s17, 20
    s_lshr_b32 s18, s18, 3
    s_sub_u32 s19, s18, 20
    s_lshl_b32 s19, s19, 1
    s_cmp_ge_u32 s18, 20
    s_cselect_b32 s18, s19, s18
    s_cselect_b32 s26, 1, 0
    s_mov_b32 s22, 4160
    s_cmov_b32 s22, 2112
    s_mov_b32 s23, 4640
    s_cmov_b32 s23, 2592
    s_mov_b32 s24, 2048
    s_cmov_b32 s24, 16896
    s_mov_b32 s25, 2048
    s_cmov_b32 s25, 20736
    s_cselect_b32 s28, 2048, 0
    s_add_u32 s17, s17, s18
    v_lshlrev_b32 v3, 4, v2
    s_lshl_b32 s18, s17, 2
    s_lshr_b32 s19, s16, 1
    s_add_u32 s18, s18, s19
    s_lshl_b32 s29, s18, 11
    s_add_u32 s29, s29, 16777216
    s_lshl_b32 s18, s18, 12
    s_add_u32 s28, s28, s18
    s_and_b32 s27, s16, 1
    s_lshl_b32 s18, s27, 2
    s_sub_u32 s28, s28, s18
    s_add_u32 s28, s28, 20971524
    s_mul_i32 s30, s16, s22
    s_mul_i32 s31, s16, s23
    s_add_u32 s31, s31, 33792
    s_mul_i32 s18, s26, 8192
    s_add_u32 s18, s18, s29
    s_mul_i32 s19, s26, 14336
    s_add_u32 s19, s19, s28
    s_add_u32 s19, s19, 2048
    s_mov_b32 m0, s30
    s_waitcnt lgkmcnt(0)
    s_mov_b32 s8, s4
    s_mov_b32 s9, s5
    s_mov_b32 s10, 0x2000000
    s_mov_b32 s11, 0x00020000
    s_cmp_ge_u32 s2, 496
    s_cbranch_scc1 C_hi
    buffer_load_dwordx4 v[48:51], v3, s[8:11], s29 offen offset:0
    buffer_load_dwordx4 v[52:55], v3, s[8:11], s29 offen offset:1024
    buffer_load_dwordx4 v[56:59], v3, s[8:11], s18 offen offset:0
    buffer_load_dwordx4 v[60:63], v3, s[8:11], s18 offen offset:1024
    buffer_load_dwordx4 v3, s[8:11], s28 offen offset:0 lds
    buffer_load_dwordx4 v3, s[8:11], s28 offen offset:1024 lds
    s_add_u32 m0, s30, s24
    s_nop 0
    buffer_load_dwordx4 v3, s[8:11], s19 offen offset:0 lds
    buffer_load_dwordx4 v3, s[8:11], s19 offen offset:1024 lds
    v_mov_b32 v14, 0
    v_mov_b32 v15, 0
    v_lshrrev_b32 v112, 5, v2
    v_and_b32 v113, 31, v2
    s_mul_i32 s18, s26, 16896
    s_add_u32 s19, s30, s24
    s_add_u32 s19, s19, 2048
    v_mul_u32_u24 v114, s18, v112
    v_sub_u32 v114, s19, v114
    v_lshl_add_u32 v115, v113, 1, v114
    ds_write_b16 v115, v14
    s_lshl_b32 s18, s27, 2
    s_sub_u32 s18, s18, 4
    v_add_u32 v9, s18, v114
    s_mul_i32 s18, s26, 20736
    v_mov_b32 v114, s31
    v_mad_u32_u24 v114, v112, s18, v114
    v_lshl_add_u32 v115, v113, 3, v114
    ds_write2_b64 v115, v[14:15], v[14:15] offset0:0 offset1:32
    v_add_u32 v116, s31, v3
    s_cmp_eq_u32 s27, 1
    s_mov_b32 s32, 0x05040302
    s_cmov_b32 s32, 0x07060504
    s_mov_b32 s33, 0x01000100
    s_cmov_b32 s33, 0x03020100
    s_mov_b32 s18, 0x03020100
    s_cmov_b32 s18, 0x03020302
    s_mov_b32 s34, 0x01000100
    s_mov_b32 s35, 0x03020302
    s_mov_b32 vcc_lo, 0xaaaaaaaa
    s_mov_b32 vcc_hi, 0xaaaaaaaa
    v_mov_b32 v118, s33
    v_mov_b32 v117, s18
    v_cndmask_b32 v118, v118, v117, vcc
    s_mov_b32 s20, 0x05040100
    s_mov_b32 s21, 0x07060302
    v_mul_u32_u24 v117, 512, v112
    v_add_u32 v117, v117, v116
    s_waitcnt vmcnt(6)
    s_cmp_eq_u32 s26, 1
    s_setprio 1
    v_mov_b32_dpp v119, v51 wave_shr:1 row_mask:0xf bank_mask:0xf bound_ctrl:0
    v_perm_b32 v81, v49, v48, s32
    v_perm_b32 v82, v50, v49, s32
    v_perm_b32 v83, v51, v50, s32
    v_perm_b32 v80, v48, v119, s32
    v_perm_b32 v84, v52, v52, s34
    v_perm_b32 v85, v52, v52, s33
    v_perm_b32 v86, v52, v52, s35
    v_perm_b32 v87, v55, v52, s32
    ds_write_b128 v116, v[80:83] offset:512
    ds_write_b128 v116, v[84:87] offset:1536
    s_cbranch_scc1 C_s
    v_perm_b32 v88, v53, v53, s34
    v_perm_b32 v89, v53, v53, s34
    v_perm_b32 v90, v53, v53, v118
    v_perm_b32 v91, v53, v53, s35
    ds_write_b128 v117, v[88:91] offset:2560
    v_perm_b32 v92, v54, v54, s34
    v_perm_b32 v93, v54, v54, s34
    v_perm_b32 v94, v54, v54, v118
    v_perm_b32 v95, v54, v54, s35
    ds_write_b128 v117, v[92:95] offset:3072
    s_branch C_j
C_s:
    s_waitcnt vmcnt(4)
    v_mov_b32_dpp v119, v59 wave_shr:1 row_mask:0xf bank_mask:0xf bound_ctrl:0
    v_perm_b32 v89, v57, v56, s32
    v_perm_b32 v90, v58, v57, s32
    v_perm_b32 v91, v59, v58, s32
    v_perm_b32 v88, v56, v119, s32
    v_perm_b32 v92, v60, v60, s34
    v_perm_b32 v93, v60, v60, s33
    v_perm_b32 v94, v60, v60, s35
    v_perm_b32 v95, v63, v60, s32
    ds_write_b128 v116, v[88:91] offset:21248
    ds_write_b128 v116, v[92:95] offset:22272
C_j:
    s_waitcnt vmcnt(0)
    ds_write_b32 v9, v14
    s_waitcnt lgkmcnt(0)
    s_barrier
    s_cmp_ge_u32 s16, 4
    s_cbranch_scc1 C_hi
    v_and_b32 v114, 1, v2
    v_bfe_u32 v115, v2, 1, 3
    v_and_b32 v119, 48, v2
    v_mad_u32_u24 v4, v114, s22, v119
    v_lshlrev_b32 v117, 3, v115
    v_sub_u32 v4, v4, v117
    s_lshl_b32 s18, s30, 1
    s_add_u32 s18, s18, 56
    v_add_u32 v4, s18, v4
    v_add_u32 v5, s24, v4
    v_mad_u32_u24 v6, v114, s23, v119
    s_lshl_b32 s18, s31, 1
    s_sub_u32 s18, s18, 33728
    v_lshl_add_u32 v6, v115, 6, v6
    v_add_u32 v6, s18, v6
    v_add_u32 v8, s25, v6
    s_setprio 0
    s_cmp_eq_u32 s26, 1
    s_cbranch_scc1 C_ls
    ds_read2_b64 v[48:51], v4 offset0:0 offset1:1
    ds_read_b128 v[80:83], v6 offset:0
    ds_read2_b64 v[52:55], v4 offset0:64 offset1:65
    ds_read_b128 v[84:87], v6 offset:512
    ds_read2_b64 v[56:59], v4 offset0:128 offset1:129
    ds_read_b128 v[88:91], v6 offset:1024
    ds_read2_b64 v[60:63], v4 offset0:192 offset1:193
    ds_read_b128 v[92:95], v6 offset:1536
    ds_read2_b64 v[64:67], v5 offset0:0 offset1:1
    ds_read_b128 v[96:99], v8 offset:0
    ds_read2_b64 v[68:71], v5 offset0:64 offset1:65
    ds_read_b128 v[100:103], v8 offset:512
    ds_read2_b64 v[72:75], v5 offset0:128 offset1:129
    ds_read_b128 v[104:107], v8 offset:1024
    ds_read2_b64 v[76:79], v5 offset0:192 offset1:193
    ds_read_b128 v[108:111], v8 offset:1536
    s_waitcnt lgkmcnt(12)
    v_mfma_f32_16x16x32_bf16 v[28:31], v[48:51], v[80:83], 0
    v_mfma_f32_16x16x32_bf16 v[24:27], v[52:55], v[80:83], 0
    v_mfma_f32_16x16x32_bf16 v[28:31], v[52:55], v[84:87], v[28:31]
    s_waitcnt lgkmcnt(8)
    v_mfma_f32_16x16x32_bf16 v[20:23], v[56:59], v[80:83], 0
    v_mfma_f32_16x16x32_bf16 v[24:27], v[56:59], v[84:87], v[24:27]
    v_mfma_f32_16x16x32_bf16 v[28:31], v[56:59], v[88:91], v[28:31]
    v_mfma_f32_16x16x32_bf16 v[16:19], v[60:63], v[80:83], 0
    v_mfma_f32_16x16x32_bf16 v[20:23], v[60:63], v[84:87], v[20:23]
    v_mfma_f32_16x16x32_bf16 v[24:27], v[60:63], v[88:91], v[24:27]
    v_mfma_f32_16x16x32_bf16 v[28:31], v[60:63], v[92:95], v[28:31]
    s_waitcnt lgkmcnt(4)
    v_mfma_f32_16x16x32_bf16 v[16:19], v[64:67], v[84:87], v[16:19]
    v_mfma_f32_16x16x32_bf16 v[20:23], v[64:67], v[88:91], v[20:23]
    v_mfma_f32_16x16x32_bf16 v[24:27], v[64:67], v[92:95], v[24:27]
    v_mfma_f32_16x16x32_bf16 v[28:31], v[64:67], v[96:99], v[28:31]
    v_mfma_f32_16x16x32_bf16 v[16:19], v[68:71], v[88:91], v[16:19]
    v_mfma_f32_16x16x32_bf16 v[20:23], v[68:71], v[92:95], v[20:23]
    v_mfma_f32_16x16x32_bf16 v[24:27], v[68:71], v[96:99], v[24:27]
    v_mfma_f32_16x16x32_bf16 v[28:31], v[68:71], v[100:103], v[28:31]
    s_waitcnt lgkmcnt(0)
    v_mfma_f32_16x16x32_bf16 v[16:19], v[72:75], v[92:95], v[16:19]
    v_mfma_f32_16x16x32_bf16 v[20:23], v[72:75], v[96:99], v[20:23]
    v_mfma_f32_16x16x32_bf16 v[24:27], v[72:75], v[100:103], v[24:27]
    v_mfma_f32_16x16x32_bf16 v[28:31], v[72:75], v[104:107], v[28:31]
    v_mfma_f32_16x16x32_bf16 v[16:19], v[76:79], v[96:99], v[16:19]
    v_mfma_f32_16x16x32_bf16 v[20:23], v[76:79], v[100:103], v[20:23]
    v_mfma_f32_16x16x32_bf16 v[24:27], v[76:79], v[104:107], v[24:27]
    v_mfma_f32_16x16x32_bf16 v[28:31], v[76:79], v[108:111], v[28:31]
    ds_read2_b64 v[48:51], v4 offset0:8 offset1:9
    ds_read_b128 v[80:83], v6 offset:64
    ds_read2_b64 v[52:55], v4 offset0:72 offset1:73
    ds_read_b128 v[84:87], v6 offset:576
    ds_read2_b64 v[56:59], v4 offset0:136 offset1:137
    ds_read_b128 v[88:91], v6 offset:1088
    ds_read2_b64 v[60:63], v4 offset0:200 offset1:201
    ds_read_b128 v[92:95], v6 offset:1600
    ds_read2_b64 v[64:67], v5 offset0:8 offset1:9
    ds_read_b128 v[96:99], v8 offset:64
    ds_read2_b64 v[68:71], v5 offset0:72 offset1:73
    ds_read_b128 v[100:103], v8 offset:576
    ds_read2_b64 v[72:75], v5 offset0:136 offset1:137
    ds_read_b128 v[104:107], v8 offset:1088
    ds_read2_b64 v[76:79], v5 offset0:200 offset1:201
    ds_read_b128 v[108:111], v8 offset:1600
    s_waitcnt lgkmcnt(12)
    v_mfma_f32_16x16x32_bf16 v[28:31], v[48:51], v[80:83], v[28:31]
    v_mfma_f32_16x16x32_bf16 v[24:27], v[52:55], v[80:83], v[24:27]
    v_mfma_f32_16x16x32_bf16 v[28:31], v[52:55], v[84:87], v[28:31]
    s_waitcnt lgkmcnt(8)
    v_mfma_f32_16x16x32_bf16 v[20:23], v[56:59], v[80:83], v[20:23]
    v_mfma_f32_16x16x32_bf16 v[24:27], v[56:59], v[84:87], v[24:27]
    v_mfma_f32_16x16x32_bf16 v[28:31], v[56:59], v[88:91], v[28:31]
    v_mfma_f32_16x16x32_bf16 v[16:19], v[60:63], v[80:83], v[16:19]
    v_mfma_f32_16x16x32_bf16 v[20:23], v[60:63], v[84:87], v[20:23]
    v_mfma_f32_16x16x32_bf16 v[24:27], v[60:63], v[88:91], v[24:27]
    v_mfma_f32_16x16x32_bf16 v[28:31], v[60:63], v[92:95], v[28:31]
    s_waitcnt lgkmcnt(4)
    v_mfma_f32_16x16x32_bf16 v[16:19], v[64:67], v[84:87], v[16:19]
    v_mfma_f32_16x16x32_bf16 v[20:23], v[64:67], v[88:91], v[20:23]
    v_mfma_f32_16x16x32_bf16 v[24:27], v[64:67], v[92:95], v[24:27]
    v_mfma_f32_16x16x32_bf16 v[28:31], v[64:67], v[96:99], v[28:31]
    v_mfma_f32_16x16x32_bf16 v[16:19], v[68:71], v[88:91], v[16:19]
    v_mfma_f32_16x16x32_bf16 v[20:23], v[68:71], v[92:95], v[20:23]
    v_mfma_f32_16x16x32_bf16 v[24:27], v[68:71], v[96:99], v[24:27]
    v_mfma_f32_16x16x32_bf16 v[28:31], v[68:71], v[100:103], v[28:31]
    s_waitcnt lgkmcnt(0)
    v_mfma_f32_16x16x32_bf16 v[16:19], v[72:75], v[92:95], v[16:19]
    v_mfma_f32_16x16x32_bf16 v[20:23], v[72:75], v[96:99], v[20:23]
    v_mfma_f32_16x16x32_bf16 v[24:27], v[72:75], v[100:103], v[24:27]
    v_mfma_f32_16x16x32_bf16 v[28:31], v[72:75], v[104:107], v[28:31]
    v_mfma_f32_16x16x32_bf16 v[16:19], v[76:79], v[96:99], v[16:19]
    v_mfma_f32_16x16x32_bf16 v[20:23], v[76:79], v[100:103], v[20:23]
    v_mfma_f32_16x16x32_bf16 v[24:27], v[76:79], v[104:107], v[24:27]
    v_mfma_f32_16x16x32_bf16 v[28:31], v[76:79], v[108:111], v[28:31]
    ds_read2_b64 v[48:51], v4 offset0:16 offset1:17
    ds_read_b128 v[80:83], v6 offset:128
    ds_read2_b64 v[52:55], v4 offset0:80 offset1:81
    ds_read_b128 v[84:87], v6 offset:640
    ds_read2_b64 v[56:59], v4 offset0:144 offset1:145
    ds_read_b128 v[88:91], v6 offset:1152
    ds_read2_b64 v[60:63], v4 offset0:208 offset1:209
    ds_read_b128 v[92:95], v6 offset:1664
    ds_read2_b64 v[64:67], v5 offset0:16 offset1:17
    ds_read_b128 v[96:99], v8 offset:128
    ds_read2_b64 v[68:71], v5 offset0:80 offset1:81
    ds_read_b128 v[100:103], v8 offset:640
    ds_read2_b64 v[72:75], v5 offset0:144 offset1:145
    ds_read_b128 v[104:107], v8 offset:1152
    ds_read2_b64 v[76:79], v5 offset0:208 offset1:209
    ds_read_b128 v[108:111], v8 offset:1664
    s_waitcnt lgkmcnt(12)
    v_mfma_f32_16x16x32_bf16 v[28:31], v[48:51], v[80:83], v[28:31]
    v_mfma_f32_16x16x32_bf16 v[24:27], v[52:55], v[80:83], v[24:27]
    v_mfma_f32_16x16x32_bf16 v[28:31], v[52:55], v[84:87], v[28:31]
    s_waitcnt lgkmcnt(8)
    v_mfma_f32_16x16x32_bf16 v[20:23], v[56:59], v[80:83], v[20:23]
    v_mfma_f32_16x16x32_bf16 v[24:27], v[56:59], v[84:87], v[24:27]
    v_mfma_f32_16x16x32_bf16 v[28:31], v[56:59], v[88:91], v[28:31]
    v_mfma_f32_16x16x32_bf16 v[16:19], v[60:63], v[80:83], v[16:19]
    v_mfma_f32_16x16x32_bf16 v[20:23], v[60:63], v[84:87], v[20:23]
    v_mfma_f32_16x16x32_bf16 v[24:27], v[60:63], v[88:91], v[24:27]
    v_mfma_f32_16x16x32_bf16 v[28:31], v[60:63], v[92:95], v[28:31]
    s_waitcnt lgkmcnt(4)
    v_mfma_f32_16x16x32_bf16 v[16:19], v[64:67], v[84:87], v[16:19]
    v_mfma_f32_16x16x32_bf16 v[20:23], v[64:67], v[88:91], v[20:23]
    v_mfma_f32_16x16x32_bf16 v[24:27], v[64:67], v[92:95], v[24:27]
    v_mfma_f32_16x16x32_bf16 v[28:31], v[64:67], v[96:99], v[28:31]
    v_mfma_f32_16x16x32_bf16 v[16:19], v[68:71], v[88:91], v[16:19]
    v_mfma_f32_16x16x32_bf16 v[20:23], v[68:71], v[92:95], v[20:23]
    v_mfma_f32_16x16x32_bf16 v[24:27], v[68:71], v[96:99], v[24:27]
    v_mfma_f32_16x16x32_bf16 v[28:31], v[68:71], v[100:103], v[28:31]
    s_waitcnt lgkmcnt(0)
    v_mfma_f32_16x16x32_bf16 v[16:19], v[72:75], v[92:95], v[16:19]
    v_mfma_f32_16x16x32_bf16 v[20:23], v[72:75], v[96:99], v[20:23]
    v_mfma_f32_16x16x32_bf16 v[24:27], v[72:75], v[100:103], v[24:27]
    v_mfma_f32_16x16x32_bf16 v[28:31], v[72:75], v[104:107], v[28:31]
    v_mfma_f32_16x16x32_bf16 v[16:19], v[76:79], v[96:99], v[16:19]
    v_mfma_f32_16x16x32_bf16 v[20:23], v[76:79], v[100:103], v[20:23]
    v_mfma_f32_16x16x32_bf16 v[24:27], v[76:79], v[104:107], v[24:27]
    v_mfma_f32_16x16x32_bf16 v[28:31], v[76:79], v[108:111], v[28:31]
    ds_read2_b64 v[48:51], v4 offset0:24 offset1:25
    ds_read_b128 v[80:83], v6 offset:192
    ds_read2_b64 v[52:55], v4 offset0:88 offset1:89
    ds_read_b128 v[84:87], v6 offset:704
    ds_read2_b64 v[56:59], v4 offset0:152 offset1:153
    ds_read_b128 v[88:91], v6 offset:1216
    ds_read2_b64 v[60:63], v4 offset0:216 offset1:217
    ds_read_b128 v[92:95], v6 offset:1728
    ds_read2_b64 v[64:67], v5 offset0:24 offset1:25
    ds_read_b128 v[96:99], v8 offset:192
    ds_read2_b64 v[68:71], v5 offset0:88 offset1:89
    ds_read_b128 v[100:103], v8 offset:704
    ds_read2_b64 v[72:75], v5 offset0:152 offset1:153
    ds_read_b128 v[104:107], v8 offset:1216
    ds_read2_b64 v[76:79], v5 offset0:216 offset1:217
    ds_read_b128 v[108:111], v8 offset:1728
    s_waitcnt lgkmcnt(12)
    v_mfma_f32_16x16x32_bf16 v[28:31], v[48:51], v[80:83], v[28:31]
    v_mfma_f32_16x16x32_bf16 v[24:27], v[52:55], v[80:83], v[24:27]
    v_mfma_f32_16x16x32_bf16 v[28:31], v[52:55], v[84:87], v[28:31]
    s_waitcnt lgkmcnt(8)
    v_mfma_f32_16x16x32_bf16 v[20:23], v[56:59], v[80:83], v[20:23]
    v_mfma_f32_16x16x32_bf16 v[24:27], v[56:59], v[84:87], v[24:27]
    v_mfma_f32_16x16x32_bf16 v[28:31], v[56:59], v[88:91], v[28:31]
    v_mfma_f32_16x16x32_bf16 v[16:19], v[60:63], v[80:83], v[16:19]
    v_mfma_f32_16x16x32_bf16 v[20:23], v[60:63], v[84:87], v[20:23]
    v_mfma_f32_16x16x32_bf16 v[24:27], v[60:63], v[88:91], v[24:27]
    v_mfma_f32_16x16x32_bf16 v[28:31], v[60:63], v[92:95], v[28:31]
    s_waitcnt lgkmcnt(4)
    v_mfma_f32_16x16x32_bf16 v[16:19], v[64:67], v[84:87], v[16:19]
    v_mfma_f32_16x16x32_bf16 v[20:23], v[64:67], v[88:91], v[20:23]
    v_mfma_f32_16x16x32_bf16 v[24:27], v[64:67], v[92:95], v[24:27]
    v_mfma_f32_16x16x32_bf16 v[28:31], v[64:67], v[96:99], v[28:31]
    v_mfma_f32_16x16x32_bf16 v[16:19], v[68:71], v[88:91], v[16:19]
    v_mfma_f32_16x16x32_bf16 v[20:23], v[68:71], v[92:95], v[20:23]
    v_mfma_f32_16x16x32_bf16 v[24:27], v[68:71], v[96:99], v[24:27]
    v_mfma_f32_16x16x32_bf16 v[28:31], v[68:71], v[100:103], v[28:31]
    s_waitcnt lgkmcnt(0)
    v_mfma_f32_16x16x32_bf16 v[16:19], v[72:75], v[92:95], v[16:19]
    v_mfma_f32_16x16x32_bf16 v[20:23], v[72:75], v[96:99], v[20:23]
    v_mfma_f32_16x16x32_bf16 v[24:27], v[72:75], v[100:103], v[24:27]
    v_mfma_f32_16x16x32_bf16 v[28:31], v[72:75], v[104:107], v[28:31]
    v_mfma_f32_16x16x32_bf16 v[16:19], v[76:79], v[96:99], v[16:19]
    v_mfma_f32_16x16x32_bf16 v[20:23], v[76:79], v[100:103], v[20:23]
    v_mfma_f32_16x16x32_bf16 v[24:27], v[76:79], v[104:107], v[24:27]
    v_mfma_f32_16x16x32_bf16 v[28:31], v[76:79], v[108:111], v[28:31]
    ds_read2_b64 v[48:51], v4 offset0:32 offset1:33
    ds_read_b128 v[80:83], v6 offset:256
    ds_read2_b64 v[52:55], v4 offset0:96 offset1:97
    ds_read_b128 v[84:87], v6 offset:768
    ds_read2_b64 v[56:59], v4 offset0:160 offset1:161
    ds_read_b128 v[88:91], v6 offset:1280
    ds_read2_b64 v[60:63], v4 offset0:224 offset1:225
    ds_read_b128 v[92:95], v6 offset:1792
    ds_read2_b64 v[64:67], v5 offset0:32 offset1:33
    ds_read_b128 v[96:99], v8 offset:256
    ds_read2_b64 v[68:71], v5 offset0:96 offset1:97
    ds_read_b128 v[100:103], v8 offset:768
    ds_read2_b64 v[72:75], v5 offset0:160 offset1:161
    ds_read_b128 v[104:107], v8 offset:1280
    ds_read2_b64 v[76:79], v5 offset0:224 offset1:225
    ds_read_b128 v[108:111], v8 offset:1792
    s_waitcnt lgkmcnt(12)
    v_mfma_f32_16x16x32_bf16 v[28:31], v[48:51], v[80:83], v[28:31]
    v_mfma_f32_16x16x32_bf16 v[24:27], v[52:55], v[80:83], v[24:27]
    v_mfma_f32_16x16x32_bf16 v[28:31], v[52:55], v[84:87], v[28:31]
    s_waitcnt lgkmcnt(8)
    v_mfma_f32_16x16x32_bf16 v[20:23], v[56:59], v[80:83], v[20:23]
    v_mfma_f32_16x16x32_bf16 v[24:27], v[56:59], v[84:87], v[24:27]
    v_mfma_f32_16x16x32_bf16 v[28:31], v[56:59], v[88:91], v[28:31]
    v_mfma_f32_16x16x32_bf16 v[16:19], v[60:63], v[80:83], v[16:19]
    v_mfma_f32_16x16x32_bf16 v[20:23], v[60:63], v[84:87], v[20:23]
    v_mfma_f32_16x16x32_bf16 v[24:27], v[60:63], v[88:91], v[24:27]
    v_mfma_f32_16x16x32_bf16 v[28:31], v[60:63], v[92:95], v[28:31]
    s_waitcnt lgkmcnt(4)
    v_mfma_f32_16x16x32_bf16 v[16:19], v[64:67], v[84:87], v[16:19]
    v_mfma_f32_16x16x32_bf16 v[20:23], v[64:67], v[88:91], v[20:23]
    v_mfma_f32_16x16x32_bf16 v[24:27], v[64:67], v[92:95], v[24:27]
    v_mfma_f32_16x16x32_bf16 v[28:31], v[64:67], v[96:99], v[28:31]
    v_mfma_f32_16x16x32_bf16 v[16:19], v[68:71], v[88:91], v[16:19]
    v_mfma_f32_16x16x32_bf16 v[20:23], v[68:71], v[92:95], v[20:23]
    v_mfma_f32_16x16x32_bf16 v[24:27], v[68:71], v[96:99], v[24:27]
    v_mfma_f32_16x16x32_bf16 v[28:31], v[68:71], v[100:103], v[28:31]
    s_waitcnt lgkmcnt(0)
    v_mfma_f32_16x16x32_bf16 v[16:19], v[72:75], v[92:95], v[16:19]
    v_mfma_f32_16x16x32_bf16 v[20:23], v[72:75], v[96:99], v[20:23]
    v_mfma_f32_16x16x32_bf16 v[24:27], v[72:75], v[100:103], v[24:27]
    v_mfma_f32_16x16x32_bf16 v[28:31], v[72:75], v[104:107], v[28:31]
    v_mfma_f32_16x16x32_bf16 v[16:19], v[76:79], v[96:99], v[16:19]
    v_mfma_f32_16x16x32_bf16 v[20:23], v[76:79], v[100:103], v[20:23]
    v_mfma_f32_16x16x32_bf16 v[24:27], v[76:79], v[104:107], v[24:27]
    v_mfma_f32_16x16x32_bf16 v[28:31], v[76:79], v[108:111], v[28:31]
    ds_read2_b64 v[48:51], v4 offset0:40 offset1:41
    ds_read_b128 v[80:83], v6 offset:320
    ds_read2_b64 v[52:55], v4 offset0:104 offset1:105
    ds_read_b128 v[84:87], v6 offset:832
    ds_read2_b64 v[56:59], v4 offset0:168 offset1:169
    ds_read_b128 v[88:91], v6 offset:1344
    ds_read2_b64 v[60:63], v4 offset0:232 offset1:233
    ds_read_b128 v[92:95], v6 offset:1856
    ds_read2_b64 v[64:67], v5 offset0:40 offset1:41
    ds_read_b128 v[96:99], v8 offset:320
    ds_read2_b64 v[68:71], v5 offset0:104 offset1:105
    ds_read_b128 v[100:103], v8 offset:832
    ds_read2_b64 v[72:75], v5 offset0:168 offset1:169
    ds_read_b128 v[104:107], v8 offset:1344
    ds_read2_b64 v[76:79], v5 offset0:232 offset1:233
    ds_read_b128 v[108:111], v8 offset:1856
    s_waitcnt lgkmcnt(12)
    v_mfma_f32_16x16x32_bf16 v[28:31], v[48:51], v[80:83], v[28:31]
    v_mfma_f32_16x16x32_bf16 v[24:27], v[52:55], v[80:83], v[24:27]
    v_mfma_f32_16x16x32_bf16 v[28:31], v[52:55], v[84:87], v[28:31]
    s_waitcnt lgkmcnt(8)
    v_mfma_f32_16x16x32_bf16 v[20:23], v[56:59], v[80:83], v[20:23]
    v_mfma_f32_16x16x32_bf16 v[24:27], v[56:59], v[84:87], v[24:27]
    v_mfma_f32_16x16x32_bf16 v[28:31], v[56:59], v[88:91], v[28:31]
    v_mfma_f32_16x16x32_bf16 v[16:19], v[60:63], v[80:83], v[16:19]
    v_mfma_f32_16x16x32_bf16 v[20:23], v[60:63], v[84:87], v[20:23]
    v_mfma_f32_16x16x32_bf16 v[24:27], v[60:63], v[88:91], v[24:27]
    v_mfma_f32_16x16x32_bf16 v[28:31], v[60:63], v[92:95], v[28:31]
    s_waitcnt lgkmcnt(4)
    v_mfma_f32_16x16x32_bf16 v[16:19], v[64:67], v[84:87], v[16:19]
    v_mfma_f32_16x16x32_bf16 v[20:23], v[64:67], v[88:91], v[20:23]
    v_mfma_f32_16x16x32_bf16 v[24:27], v[64:67], v[92:95], v[24:27]
    v_mfma_f32_16x16x32_bf16 v[28:31], v[64:67], v[96:99], v[28:31]
    v_mfma_f32_16x16x32_bf16 v[16:19], v[68:71], v[88:91], v[16:19]
    v_mfma_f32_16x16x32_bf16 v[20:23], v[68:71], v[92:95], v[20:23]
    v_mfma_f32_16x16x32_bf16 v[24:27], v[68:71], v[96:99], v[24:27]
    v_mfma_f32_16x16x32_bf16 v[28:31], v[68:71], v[100:103], v[28:31]
    s_waitcnt lgkmcnt(0)
    v_mfma_f32_16x16x32_bf16 v[16:19], v[72:75], v[92:95], v[16:19]
    v_mfma_f32_16x16x32_bf16 v[20:23], v[72:75], v[96:99], v[20:23]
    v_mfma_f32_16x16x32_bf16 v[24:27], v[72:75], v[100:103], v[24:27]
    v_mfma_f32_16x16x32_bf16 v[28:31], v[72:75], v[104:107], v[28:31]
    v_mfma_f32_16x16x32_bf16 v[16:19], v[76:79], v[96:99], v[16:19]
    v_mfma_f32_16x16x32_bf16 v[20:23], v[76:79], v[100:103], v[20:23]
    v_mfma_f32_16x16x32_bf16 v[24:27], v[76:79], v[104:107], v[24:27]
    v_mfma_f32_16x16x32_bf16 v[28:31], v[76:79], v[108:111], v[28:31]
    ds_read2_b64 v[48:51], v4 offset0:48 offset1:49
    ds_read_b128 v[80:83], v6 offset:384
    ds_read2_b64 v[52:55], v4 offset0:112 offset1:113
    ds_read_b128 v[84:87], v6 offset:896
    ds_read2_b64 v[56:59], v4 offset0:176 offset1:177
    ds_read_b128 v[88:91], v6 offset:1408
    ds_read2_b64 v[60:63], v4 offset0:240 offset1:241
    ds_read_b128 v[92:95], v6 offset:1920
    ds_read2_b64 v[64:67], v5 offset0:48 offset1:49
    ds_read_b128 v[96:99], v8 offset:384
    ds_read2_b64 v[68:71], v5 offset0:112 offset1:113
    ds_read_b128 v[100:103], v8 offset:896
    ds_read2_b64 v[72:75], v5 offset0:176 offset1:177
    ds_read_b128 v[104:107], v8 offset:1408
    ds_read2_b64 v[76:79], v5 offset0:240 offset1:241
    ds_read_b128 v[108:111], v8 offset:1920
    s_waitcnt lgkmcnt(12)
    v_mfma_f32_16x16x32_bf16 v[28:31], v[48:51], v[80:83], v[28:31]
    v_mfma_f32_16x16x32_bf16 v[24:27], v[52:55], v[80:83], v[24:27]
    v_mfma_f32_16x16x32_bf16 v[28:31], v[52:55], v[84:87], v[28:31]
    s_waitcnt lgkmcnt(8)
    v_mfma_f32_16x16x32_bf16 v[20:23], v[56:59], v[80:83], v[20:23]
    v_mfma_f32_16x16x32_bf16 v[24:27], v[56:59], v[84:87], v[24:27]
    v_mfma_f32_16x16x32_bf16 v[28:31], v[56:59], v[88:91], v[28:31]
    v_mfma_f32_16x16x32_bf16 v[16:19], v[60:63], v[80:83], v[16:19]
    v_mfma_f32_16x16x32_bf16 v[20:23], v[60:63], v[84:87], v[20:23]
    v_mfma_f32_16x16x32_bf16 v[24:27], v[60:63], v[88:91], v[24:27]
    v_mfma_f32_16x16x32_bf16 v[28:31], v[60:63], v[92:95], v[28:31]
    s_waitcnt lgkmcnt(4)
    v_mfma_f32_16x16x32_bf16 v[16:19], v[64:67], v[84:87], v[16:19]
    v_mfma_f32_16x16x32_bf16 v[20:23], v[64:67], v[88:91], v[20:23]
    v_mfma_f32_16x16x32_bf16 v[24:27], v[64:67], v[92:95], v[24:27]
    v_mfma_f32_16x16x32_bf16 v[28:31], v[64:67], v[96:99], v[28:31]
    v_mfma_f32_16x16x32_bf16 v[16:19], v[68:71], v[88:91], v[16:19]
    v_mfma_f32_16x16x32_bf16 v[20:23], v[68:71], v[92:95], v[20:23]
    v_mfma_f32_16x16x32_bf16 v[24:27], v[68:71], v[96:99], v[24:27]
    v_mfma_f32_16x16x32_bf16 v[28:31], v[68:71], v[100:103], v[28:31]
    s_waitcnt lgkmcnt(0)
    v_mfma_f32_16x16x32_bf16 v[16:19], v[72:75], v[92:95], v[16:19]
    v_mfma_f32_16x16x32_bf16 v[20:23], v[72:75], v[96:99], v[20:23]
    v_mfma_f32_16x16x32_bf16 v[24:27], v[72:75], v[100:103], v[24:27]
    v_mfma_f32_16x16x32_bf16 v[28:31], v[72:75], v[104:107], v[28:31]
    v_mfma_f32_16x16x32_bf16 v[16:19], v[76:79], v[96:99], v[16:19]
    v_mfma_f32_16x16x32_bf16 v[20:23], v[76:79], v[100:103], v[20:23]
    v_mfma_f32_16x16x32_bf16 v[24:27], v[76:79], v[104:107], v[24:27]
    v_mfma_f32_16x16x32_bf16 v[28:31], v[76:79], v[108:111], v[28:31]
    ds_read2_b64 v[48:51], v4 offset0:56 offset1:57
    ds_read_b128 v[80:83], v6 offset:448
    ds_read2_b64 v[52:55], v4 offset0:120 offset1:121
    ds_read_b128 v[84:87], v6 offset:960
    ds_read2_b64 v[56:59], v4 offset0:184 offset1:185
    ds_read_b128 v[88:91], v6 offset:1472
    ds_read2_b64 v[60:63], v4 offset0:248 offset1:249
    ds_read_b128 v[92:95], v6 offset:1984
    ds_read2_b64 v[64:67], v5 offset0:56 offset1:57
    ds_read_b128 v[96:99], v8 offset:448
    ds_read2_b64 v[68:71], v5 offset0:120 offset1:121
    ds_read_b128 v[100:103], v8 offset:960
    ds_read2_b64 v[72:75], v5 offset0:184 offset1:185
    ds_read_b128 v[104:107], v8 offset:1472
    ds_read2_b64 v[76:79], v5 offset0:248 offset1:249
    ds_read_b128 v[108:111], v8 offset:1984
    s_waitcnt lgkmcnt(12)
    v_mfma_f32_16x16x32_bf16 v[28:31], v[48:51], v[80:83], v[28:31]
    v_mfma_f32_16x16x32_bf16 v[24:27], v[52:55], v[80:83], v[24:27]
    v_mfma_f32_16x16x32_bf16 v[28:31], v[52:55], v[84:87], v[28:31]
    s_waitcnt lgkmcnt(8)
    v_mfma_f32_16x16x32_bf16 v[20:23], v[56:59], v[80:83], v[20:23]
    v_mfma_f32_16x16x32_bf16 v[24:27], v[56:59], v[84:87], v[24:27]
    v_mfma_f32_16x16x32_bf16 v[28:31], v[56:59], v[88:91], v[28:31]
    v_mfma_f32_16x16x32_bf16 v[16:19], v[60:63], v[80:83], v[16:19]
    v_mfma_f32_16x16x32_bf16 v[20:23], v[60:63], v[84:87], v[20:23]
    v_mfma_f32_16x16x32_bf16 v[24:27], v[60:63], v[88:91], v[24:27]
    v_mfma_f32_16x16x32_bf16 v[28:31], v[60:63], v[92:95], v[28:31]
    s_waitcnt lgkmcnt(4)
    v_mfma_f32_16x16x32_bf16 v[16:19], v[64:67], v[84:87], v[16:19]
    v_mfma_f32_16x16x32_bf16 v[20:23], v[64:67], v[88:91], v[20:23]
    v_mfma_f32_16x16x32_bf16 v[24:27], v[64:67], v[92:95], v[24:27]
    v_mfma_f32_16x16x32_bf16 v[28:31], v[64:67], v[96:99], v[28:31]
    v_mfma_f32_16x16x32_bf16 v[16:19], v[68:71], v[88:91], v[16:19]
    v_mfma_f32_16x16x32_bf16 v[20:23], v[68:71], v[92:95], v[20:23]
    v_mfma_f32_16x16x32_bf16 v[24:27], v[68:71], v[96:99], v[24:27]
    v_mfma_f32_16x16x32_bf16 v[28:31], v[68:71], v[100:103], v[28:31]
    s_waitcnt lgkmcnt(0)
    v_mfma_f32_16x16x32_bf16 v[16:19], v[72:75], v[92:95], v[16:19]
    v_mfma_f32_16x16x32_bf16 v[20:23], v[72:75], v[96:99], v[20:23]
    v_mfma_f32_16x16x32_bf16 v[24:27], v[72:75], v[100:103], v[24:27]
    v_mfma_f32_16x16x32_bf16 v[28:31], v[72:75], v[104:107], v[28:31]
    v_mfma_f32_16x16x32_bf16 v[16:19], v[76:79], v[96:99], v[16:19]
    v_mfma_f32_16x16x32_bf16 v[20:23], v[76:79], v[100:103], v[20:23]
    v_mfma_f32_16x16x32_bf16 v[24:27], v[76:79], v[104:107], v[24:27]
    v_mfma_f32_16x16x32_bf16 v[28:31], v[76:79], v[108:111], v[28:31]
    s_branch C_le
C_ls:
    ds_read2_b64 v[48:51], v4 offset0:0 offset1:1
    ds_read_b128 v[80:83], v6 offset:0
    ds_read2_b64 v[52:55], v4 offset0:64 offset1:65
    ds_read_b128 v[84:87], v6 offset:512
    ds_read2_b64 v[56:59], v4 offset0:128 offset1:129
    ds_read_b128 v[88:91], v6 offset:1024
    ds_read2_b64 v[60:63], v4 offset0:192 offset1:193
    ds_read_b128 v[92:95], v6 offset:1536
    ds_read2_b64 v[64:67], v5 offset0:0 offset1:1
    ds_read_b128 v[96:99], v8 offset:0
    ds_read2_b64 v[68:71], v5 offset0:64 offset1:65
    ds_read_b128 v[100:103], v8 offset:512
    ds_read2_b64 v[72:75], v5 offset0:128 offset1:129
    ds_read_b128 v[104:107], v8 offset:1024
    ds_read2_b64 v[76:79], v5 offset0:192 offset1:193
    ds_read_b128 v[108:111], v8 offset:1536
    s_waitcnt lgkmcnt(12)
    v_mfma_f32_16x16x32_bf16 v[28:31], v[48:51], v[80:83], 0
    v_mfma_f32_16x16x32_bf16 v[24:27], v[52:55], v[80:83], 0
    v_mfma_f32_16x16x32_bf16 v[28:31], v[52:55], v[84:87], v[28:31]
    s_waitcnt lgkmcnt(8)
    v_mfma_f32_16x16x32_bf16 v[20:23], v[56:59], v[80:83], 0
    v_mfma_f32_16x16x32_bf16 v[24:27], v[56:59], v[84:87], v[24:27]
    v_mfma_f32_16x16x32_bf16 v[28:31], v[56:59], v[88:91], v[28:31]
    v_mfma_f32_16x16x32_bf16 v[16:19], v[60:63], v[80:83], 0
    v_mfma_f32_16x16x32_bf16 v[20:23], v[60:63], v[84:87], v[20:23]
    v_mfma_f32_16x16x32_bf16 v[24:27], v[60:63], v[88:91], v[24:27]
    v_mfma_f32_16x16x32_bf16 v[28:31], v[60:63], v[92:95], v[28:31]
    s_waitcnt lgkmcnt(4)
    v_mfma_f32_16x16x32_bf16 v[44:47], v[64:67], v[96:99], 0
    v_mfma_f32_16x16x32_bf16 v[40:43], v[68:71], v[96:99], 0
    v_mfma_f32_16x16x32_bf16 v[44:47], v[68:71], v[100:103], v[44:47]
    s_waitcnt lgkmcnt(0)
    v_mfma_f32_16x16x32_bf16 v[36:39], v[72:75], v[96:99], 0
    v_mfma_f32_16x16x32_bf16 v[40:43], v[72:75], v[100:103], v[40:43]
    v_mfma_f32_16x16x32_bf16 v[44:47], v[72:75], v[104:107], v[44:47]
    v_mfma_f32_16x16x32_bf16 v[32:35], v[76:79], v[96:99], 0
    v_mfma_f32_16x16x32_bf16 v[36:39], v[76:79], v[100:103], v[36:39]
    v_mfma_f32_16x16x32_bf16 v[40:43], v[76:79], v[104:107], v[40:43]
    v_mfma_f32_16x16x32_bf16 v[44:47], v[76:79], v[108:111], v[44:47]
    ds_read2_b64 v[48:51], v4 offset0:8 offset1:9
    ds_read_b128 v[80:83], v6 offset:64
    ds_read2_b64 v[52:55], v4 offset0:72 offset1:73
    ds_read_b128 v[84:87], v6 offset:576
    ds_read2_b64 v[56:59], v4 offset0:136 offset1:137
    ds_read_b128 v[88:91], v6 offset:1088
    ds_read2_b64 v[60:63], v4 offset0:200 offset1:201
    ds_read_b128 v[92:95], v6 offset:1600
    ds_read2_b64 v[64:67], v5 offset0:8 offset1:9
    ds_read_b128 v[96:99], v8 offset:64
    ds_read2_b64 v[68:71], v5 offset0:72 offset1:73
    ds_read_b128 v[100:103], v8 offset:576
    ds_read2_b64 v[72:75], v5 offset0:136 offset1:137
    ds_read_b128 v[104:107], v8 offset:1088
    ds_read2_b64 v[76:79], v5 offset0:200 offset1:201
    ds_read_b128 v[108:111], v8 offset:1600
    s_waitcnt lgkmcnt(12)
    v_mfma_f32_16x16x32_bf16 v[28:31], v[48:51], v[80:83], v[28:31]
    v_mfma_f32_16x16x32_bf16 v[24:27], v[52:55], v[80:83], v[24:27]
    v_mfma_f32_16x16x32_bf16 v[28:31], v[52:55], v[84:87], v[28:31]
    s_waitcnt lgkmcnt(8)
    v_mfma_f32_16x16x32_bf16 v[20:23], v[56:59], v[80:83], v[20:23]
    v_mfma_f32_16x16x32_bf16 v[24:27], v[56:59], v[84:87], v[24:27]
    v_mfma_f32_16x16x32_bf16 v[28:31], v[56:59], v[88:91], v[28:31]
    v_mfma_f32_16x16x32_bf16 v[16:19], v[60:63], v[80:83], v[16:19]
    v_mfma_f32_16x16x32_bf16 v[20:23], v[60:63], v[84:87], v[20:23]
    v_mfma_f32_16x16x32_bf16 v[24:27], v[60:63], v[88:91], v[24:27]
    v_mfma_f32_16x16x32_bf16 v[28:31], v[60:63], v[92:95], v[28:31]
    s_waitcnt lgkmcnt(4)
    v_mfma_f32_16x16x32_bf16 v[44:47], v[64:67], v[96:99], v[44:47]
    v_mfma_f32_16x16x32_bf16 v[40:43], v[68:71], v[96:99], v[40:43]
    v_mfma_f32_16x16x32_bf16 v[44:47], v[68:71], v[100:103], v[44:47]
    s_waitcnt lgkmcnt(0)
    v_mfma_f32_16x16x32_bf16 v[36:39], v[72:75], v[96:99], v[36:39]
    v_mfma_f32_16x16x32_bf16 v[40:43], v[72:75], v[100:103], v[40:43]
    v_mfma_f32_16x16x32_bf16 v[44:47], v[72:75], v[104:107], v[44:47]
    v_mfma_f32_16x16x32_bf16 v[32:35], v[76:79], v[96:99], v[32:35]
    v_mfma_f32_16x16x32_bf16 v[36:39], v[76:79], v[100:103], v[36:39]
    v_mfma_f32_16x16x32_bf16 v[40:43], v[76:79], v[104:107], v[40:43]
    v_mfma_f32_16x16x32_bf16 v[44:47], v[76:79], v[108:111], v[44:47]
    ds_read2_b64 v[48:51], v4 offset0:16 offset1:17
    ds_read_b128 v[80:83], v6 offset:128
    ds_read2_b64 v[52:55], v4 offset0:80 offset1:81
    ds_read_b128 v[84:87], v6 offset:640
    ds_read2_b64 v[56:59], v4 offset0:144 offset1:145
    ds_read_b128 v[88:91], v6 offset:1152
    ds_read2_b64 v[60:63], v4 offset0:208 offset1:209
    ds_read_b128 v[92:95], v6 offset:1664
    ds_read2_b64 v[64:67], v5 offset0:16 offset1:17
    ds_read_b128 v[96:99], v8 offset:128
    ds_read2_b64 v[68:71], v5 offset0:80 offset1:81
    ds_read_b128 v[100:103], v8 offset:640
    ds_read2_b64 v[72:75], v5 offset0:144 offset1:145
    ds_read_b128 v[104:107], v8 offset:1152
    ds_read2_b64 v[76:79], v5 offset0:208 offset1:209
    ds_read_b128 v[108:111], v8 offset:1664
    s_waitcnt lgkmcnt(12)
    v_mfma_f32_16x16x32_bf16 v[28:31], v[48:51], v[80:83], v[28:31]
    v_mfma_f32_16x16x32_bf16 v[24:27], v[52:55], v[80:83], v[24:27]
    v_mfma_f32_16x16x32_bf16 v[28:31], v[52:55], v[84:87], v[28:31]
    s_waitcnt lgkmcnt(8)
    v_mfma_f32_16x16x32_bf16 v[20:23], v[56:59], v[80:83], v[20:23]
    v_mfma_f32_16x16x32_bf16 v[24:27], v[56:59], v[84:87], v[24:27]
    v_mfma_f32_16x16x32_bf16 v[28:31], v[56:59], v[88:91], v[28:31]
    v_mfma_f32_16x16x32_bf16 v[16:19], v[60:63], v[80:83], v[16:19]
    v_mfma_f32_16x16x32_bf16 v[20:23], v[60:63], v[84:87], v[20:23]
    v_mfma_f32_16x16x32_bf16 v[24:27], v[60:63], v[88:91], v[24:27]
    v_mfma_f32_16x16x32_bf16 v[28:31], v[60:63], v[92:95], v[28:31]
    s_waitcnt lgkmcnt(4)
    v_mfma_f32_16x16x32_bf16 v[44:47], v[64:67], v[96:99], v[44:47]
    v_mfma_f32_16x16x32_bf16 v[40:43], v[68:71], v[96:99], v[40:43]
    v_mfma_f32_16x16x32_bf16 v[44:47], v[68:71], v[100:103], v[44:47]
    s_waitcnt lgkmcnt(0)
    v_mfma_f32_16x16x32_bf16 v[36:39], v[72:75], v[96:99], v[36:39]
    v_mfma_f32_16x16x32_bf16 v[40:43], v[72:75], v[100:103], v[40:43]
    v_mfma_f32_16x16x32_bf16 v[44:47], v[72:75], v[104:107], v[44:47]
    v_mfma_f32_16x16x32_bf16 v[32:35], v[76:79], v[96:99], v[32:35]
    v_mfma_f32_16x16x32_bf16 v[36:39], v[76:79], v[100:103], v[36:39]
    v_mfma_f32_16x16x32_bf16 v[40:43], v[76:79], v[104:107], v[40:43]
    v_mfma_f32_16x16x32_bf16 v[44:47], v[76:79], v[108:111], v[44:47]
    ds_read2_b64 v[48:51], v4 offset0:24 offset1:25
    ds_read_b128 v[80:83], v6 offset:192
    ds_read2_b64 v[52:55], v4 offset0:88 offset1:89
    ds_read_b128 v[84:87], v6 offset:704
    ds_read2_b64 v[56:59], v4 offset0:152 offset1:153
    ds_read_b128 v[88:91], v6 offset:1216
    ds_read2_b64 v[60:63], v4 offset0:216 offset1:217
    ds_read_b128 v[92:95], v6 offset:1728
    ds_read2_b64 v[64:67], v5 offset0:24 offset1:25
    ds_read_b128 v[96:99], v8 offset:192
    ds_read2_b64 v[68:71], v5 offset0:88 offset1:89
    ds_read_b128 v[100:103], v8 offset:704
    ds_read2_b64 v[72:75], v5 offset0:152 offset1:153
    ds_read_b128 v[104:107], v8 offset:1216
    ds_read2_b64 v[76:79], v5 offset0:216 offset1:217
    ds_read_b128 v[108:111], v8 offset:1728
    s_waitcnt lgkmcnt(12)
    v_mfma_f32_16x16x32_bf16 v[28:31], v[48:51], v[80:83], v[28:31]
    v_mfma_f32_16x16x32_bf16 v[24:27], v[52:55], v[80:83], v[24:27]
    v_mfma_f32_16x16x32_bf16 v[28:31], v[52:55], v[84:87], v[28:31]
    s_waitcnt lgkmcnt(8)
    v_mfma_f32_16x16x32_bf16 v[20:23], v[56:59], v[80:83], v[20:23]
    v_mfma_f32_16x16x32_bf16 v[24:27], v[56:59], v[84:87], v[24:27]
    v_mfma_f32_16x16x32_bf16 v[28:31], v[56:59], v[88:91], v[28:31]
    v_mfma_f32_16x16x32_bf16 v[16:19], v[60:63], v[80:83], v[16:19]
    v_mfma_f32_16x16x32_bf16 v[20:23], v[60:63], v[84:87], v[20:23]
    v_mfma_f32_16x16x32_bf16 v[24:27], v[60:63], v[88:91], v[24:27]
    v_mfma_f32_16x16x32_bf16 v[28:31], v[60:63], v[92:95], v[28:31]
    s_waitcnt lgkmcnt(4)
    v_mfma_f32_16x16x32_bf16 v[44:47], v[64:67], v[96:99], v[44:47]
    v_mfma_f32_16x16x32_bf16 v[40:43], v[68:71], v[96:99], v[40:43]
    v_mfma_f32_16x16x32_bf16 v[44:47], v[68:71], v[100:103], v[44:47]
    s_waitcnt lgkmcnt(0)
    v_mfma_f32_16x16x32_bf16 v[36:39], v[72:75], v[96:99], v[36:39]
    v_mfma_f32_16x16x32_bf16 v[40:43], v[72:75], v[100:103], v[40:43]
    v_mfma_f32_16x16x32_bf16 v[44:47], v[72:75], v[104:107], v[44:47]
    v_mfma_f32_16x16x32_bf16 v[32:35], v[76:79], v[96:99], v[32:35]
    v_mfma_f32_16x16x32_bf16 v[36:39], v[76:79], v[100:103], v[36:39]
    v_mfma_f32_16x16x32_bf16 v[40:43], v[76:79], v[104:107], v[40:43]
    v_mfma_f32_16x16x32_bf16 v[44:47], v[76:79], v[108:111], v[44:47]
    ds_read2_b64 v[48:51], v4 offset0:32 offset1:33
    ds_read_b128 v[80:83], v6 offset:256
    ds_read2_b64 v[52:55], v4 offset0:96 offset1:97
    ds_read_b128 v[84:87], v6 offset:768
    ds_read2_b64 v[56:59], v4 offset0:160 offset1:161
    ds_read_b128 v[88:91], v6 offset:1280
    ds_read2_b64 v[60:63], v4 offset0:224 offset1:225
    ds_read_b128 v[92:95], v6 offset:1792
    ds_read2_b64 v[64:67], v5 offset0:32 offset1:33
    ds_read_b128 v[96:99], v8 offset:256
    ds_read2_b64 v[68:71], v5 offset0:96 offset1:97
    ds_read_b128 v[100:103], v8 offset:768
    ds_read2_b64 v[72:75], v5 offset0:160 offset1:161
    ds_read_b128 v[104:107], v8 offset:1280
    ds_read2_b64 v[76:79], v5 offset0:224 offset1:225
    ds_read_b128 v[108:111], v8 offset:1792
    s_waitcnt lgkmcnt(12)
    v_mfma_f32_16x16x32_bf16 v[28:31], v[48:51], v[80:83], v[28:31]
    v_mfma_f32_16x16x32_bf16 v[24:27], v[52:55], v[80:83], v[24:27]
    v_mfma_f32_16x16x32_bf16 v[28:31], v[52:55], v[84:87], v[28:31]
    s_waitcnt lgkmcnt(8)
    v_mfma_f32_16x16x32_bf16 v[20:23], v[56:59], v[80:83], v[20:23]
    v_mfma_f32_16x16x32_bf16 v[24:27], v[56:59], v[84:87], v[24:27]
    v_mfma_f32_16x16x32_bf16 v[28:31], v[56:59], v[88:91], v[28:31]
    v_mfma_f32_16x16x32_bf16 v[16:19], v[60:63], v[80:83], v[16:19]
    v_mfma_f32_16x16x32_bf16 v[20:23], v[60:63], v[84:87], v[20:23]
    v_mfma_f32_16x16x32_bf16 v[24:27], v[60:63], v[88:91], v[24:27]
    v_mfma_f32_16x16x32_bf16 v[28:31], v[60:63], v[92:95], v[28:31]
    s_waitcnt lgkmcnt(4)
    v_mfma_f32_16x16x32_bf16 v[44:47], v[64:67], v[96:99], v[44:47]
    v_mfma_f32_16x16x32_bf16 v[40:43], v[68:71], v[96:99], v[40:43]
    v_mfma_f32_16x16x32_bf16 v[44:47], v[68:71], v[100:103], v[44:47]
    s_waitcnt lgkmcnt(0)
    v_mfma_f32_16x16x32_bf16 v[36:39], v[72:75], v[96:99], v[36:39]
    v_mfma_f32_16x16x32_bf16 v[40:43], v[72:75], v[100:103], v[40:43]
    v_mfma_f32_16x16x32_bf16 v[44:47], v[72:75], v[104:107], v[44:47]
    v_mfma_f32_16x16x32_bf16 v[32:35], v[76:79], v[96:99], v[32:35]
    v_mfma_f32_16x16x32_bf16 v[36:39], v[76:79], v[100:103], v[36:39]
    v_mfma_f32_16x16x32_bf16 v[40:43], v[76:79], v[104:107], v[40:43]
    v_mfma_f32_16x16x32_bf16 v[44:47], v[76:79], v[108:111], v[44:47]
    ds_read2_b64 v[48:51], v4 offset0:40 offset1:41
    ds_read_b128 v[80:83], v6 offset:320
    ds_read2_b64 v[52:55], v4 offset0:104 offset1:105
    ds_read_b128 v[84:87], v6 offset:832
    ds_read2_b64 v[56:59], v4 offset0:168 offset1:169
    ds_read_b128 v[88:91], v6 offset:1344
    ds_read2_b64 v[60:63], v4 offset0:232 offset1:233
    ds_read_b128 v[92:95], v6 offset:1856
    ds_read2_b64 v[64:67], v5 offset0:40 offset1:41
    ds_read_b128 v[96:99], v8 offset:320
    ds_read2_b64 v[68:71], v5 offset0:104 offset1:105
    ds_read_b128 v[100:103], v8 offset:832
    ds_read2_b64 v[72:75], v5 offset0:168 offset1:169
    ds_read_b128 v[104:107], v8 offset:1344
    ds_read2_b64 v[76:79], v5 offset0:232 offset1:233
    ds_read_b128 v[108:111], v8 offset:1856
    s_waitcnt lgkmcnt(12)
    v_mfma_f32_16x16x32_bf16 v[28:31], v[48:51], v[80:83], v[28:31]
    v_mfma_f32_16x16x32_bf16 v[24:27], v[52:55], v[80:83], v[24:27]
    v_mfma_f32_16x16x32_bf16 v[28:31], v[52:55], v[84:87], v[28:31]
    s_waitcnt lgkmcnt(8)
    v_mfma_f32_16x16x32_bf16 v[20:23], v[56:59], v[80:83], v[20:23]
    v_mfma_f32_16x16x32_bf16 v[24:27], v[56:59], v[84:87], v[24:27]
    v_mfma_f32_16x16x32_bf16 v[28:31], v[56:59], v[88:91], v[28:31]
    v_mfma_f32_16x16x32_bf16 v[16:19], v[60:63], v[80:83], v[16:19]
    v_mfma_f32_16x16x32_bf16 v[20:23], v[60:63], v[84:87], v[20:23]
    v_mfma_f32_16x16x32_bf16 v[24:27], v[60:63], v[88:91], v[24:27]
    v_mfma_f32_16x16x32_bf16 v[28:31], v[60:63], v[92:95], v[28:31]
    s_waitcnt lgkmcnt(4)
    v_mfma_f32_16x16x32_bf16 v[44:47], v[64:67], v[96:99], v[44:47]
    v_mfma_f32_16x16x32_bf16 v[40:43], v[68:71], v[96:99], v[40:43]
    v_mfma_f32_16x16x32_bf16 v[44:47], v[68:71], v[100:103], v[44:47]
    s_waitcnt lgkmcnt(0)
    v_mfma_f32_16x16x32_bf16 v[36:39], v[72:75], v[96:99], v[36:39]
    v_mfma_f32_16x16x32_bf16 v[40:43], v[72:75], v[100:103], v[40:43]
    v_mfma_f32_16x16x32_bf16 v[44:47], v[72:75], v[104:107], v[44:47]
    v_mfma_f32_16x16x32_bf16 v[32:35], v[76:79], v[96:99], v[32:35]
    v_mfma_f32_16x16x32_bf16 v[36:39], v[76:79], v[100:103], v[36:39]
    v_mfma_f32_16x16x32_bf16 v[40:43], v[76:79], v[104:107], v[40:43]
    v_mfma_f32_16x16x32_bf16 v[44:47], v[76:79], v[108:111], v[44:47]
    ds_read2_b64 v[48:51], v4 offset0:48 offset1:49
    ds_read_b128 v[80:83], v6 offset:384
    ds_read2_b64 v[52:55], v4 offset0:112 offset1:113
    ds_read_b128 v[84:87], v6 offset:896
    ds_read2_b64 v[56:59], v4 offset0:176 offset1:177
    ds_read_b128 v[88:91], v6 offset:1408
    ds_read2_b64 v[60:63], v4 offset0:240 offset1:241
    ds_read_b128 v[92:95], v6 offset:1920
    ds_read2_b64 v[64:67], v5 offset0:48 offset1:49
    ds_read_b128 v[96:99], v8 offset:384
    ds_read2_b64 v[68:71], v5 offset0:112 offset1:113
    ds_read_b128 v[100:103], v8 offset:896
    ds_read2_b64 v[72:75], v5 offset0:176 offset1:177
    ds_read_b128 v[104:107], v8 offset:1408
    ds_read2_b64 v[76:79], v5 offset0:240 offset1:241
    ds_read_b128 v[108:111], v8 offset:1920
    s_waitcnt lgkmcnt(12)
    v_mfma_f32_16x16x32_bf16 v[28:31], v[48:51], v[80:83], v[28:31]
    v_mfma_f32_16x16x32_bf16 v[24:27], v[52:55], v[80:83], v[24:27]
    v_mfma_f32_16x16x32_bf16 v[28:31], v[52:55], v[84:87], v[28:31]
    s_waitcnt lgkmcnt(8)
    v_mfma_f32_16x16x32_bf16 v[20:23], v[56:59], v[80:83], v[20:23]
    v_mfma_f32_16x16x32_bf16 v[24:27], v[56:59], v[84:87], v[24:27]
    v_mfma_f32_16x16x32_bf16 v[28:31], v[56:59], v[88:91], v[28:31]
    v_mfma_f32_16x16x32_bf16 v[16:19], v[60:63], v[80:83], v[16:19]
    v_mfma_f32_16x16x32_bf16 v[20:23], v[60:63], v[84:87], v[20:23]
    v_mfma_f32_16x16x32_bf16 v[24:27], v[60:63], v[88:91], v[24:27]
    v_mfma_f32_16x16x32_bf16 v[28:31], v[60:63], v[92:95], v[28:31]
    s_waitcnt lgkmcnt(4)
    v_mfma_f32_16x16x32_bf16 v[44:47], v[64:67], v[96:99], v[44:47]
    v_mfma_f32_16x16x32_bf16 v[40:43], v[68:71], v[96:99], v[40:43]
    v_mfma_f32_16x16x32_bf16 v[44:47], v[68:71], v[100:103], v[44:47]
    s_waitcnt lgkmcnt(0)
    v_mfma_f32_16x16x32_bf16 v[36:39], v[72:75], v[96:99], v[36:39]
    v_mfma_f32_16x16x32_bf16 v[40:43], v[72:75], v[100:103], v[40:43]
    v_mfma_f32_16x16x32_bf16 v[44:47], v[72:75], v[104:107], v[44:47]
    v_mfma_f32_16x16x32_bf16 v[32:35], v[76:79], v[96:99], v[32:35]
    v_mfma_f32_16x16x32_bf16 v[36:39], v[76:79], v[100:103], v[36:39]
    v_mfma_f32_16x16x32_bf16 v[40:43], v[76:79], v[104:107], v[40:43]
    v_mfma_f32_16x16x32_bf16 v[44:47], v[76:79], v[108:111], v[44:47]
    ds_read2_b64 v[48:51], v4 offset0:56 offset1:57
    ds_read_b128 v[80:83], v6 offset:448
    ds_read2_b64 v[52:55], v4 offset0:120 offset1:121
    ds_read_b128 v[84:87], v6 offset:960
    ds_read2_b64 v[56:59], v4 offset0:184 offset1:185
    ds_read_b128 v[88:91], v6 offset:1472
    ds_read2_b64 v[60:63], v4 offset0:248 offset1:249
    ds_read_b128 v[92:95], v6 offset:1984
    ds_read2_b64 v[64:67], v5 offset0:56 offset1:57
    ds_read_b128 v[96:99], v8 offset:448
    ds_read2_b64 v[68:71], v5 offset0:120 offset1:121
    ds_read_b128 v[100:103], v8 offset:960
    ds_read2_b64 v[72:75], v5 offset0:184 offset1:185
    ds_read_b128 v[104:107], v8 offset:1472
    ds_read2_b64 v[76:79], v5 offset0:248 offset1:249
    ds_read_b128 v[108:111], v8 offset:1984
    s_waitcnt lgkmcnt(12)
    v_mfma_f32_16x16x32_bf16 v[28:31], v[48:51], v[80:83], v[28:31]
    v_mfma_f32_16x16x32_bf16 v[24:27], v[52:55], v[80:83], v[24:27]
    v_mfma_f32_16x16x32_bf16 v[28:31], v[52:55], v[84:87], v[28:31]
    s_waitcnt lgkmcnt(8)
    v_mfma_f32_16x16x32_bf16 v[20:23], v[56:59], v[80:83], v[20:23]
    v_mfma_f32_16x16x32_bf16 v[24:27], v[56:59], v[84:87], v[24:27]
    v_mfma_f32_16x16x32_bf16 v[28:31], v[56:59], v[88:91], v[28:31]
    v_mfma_f32_16x16x32_bf16 v[16:19], v[60:63], v[80:83], v[16:19]
    v_mfma_f32_16x16x32_bf16 v[20:23], v[60:63], v[84:87], v[20:23]
    v_mfma_f32_16x16x32_bf16 v[24:27], v[60:63], v[88:91], v[24:27]
    v_mfma_f32_16x16x32_bf16 v[28:31], v[60:63], v[92:95], v[28:31]
    s_waitcnt lgkmcnt(4)
    v_mfma_f32_16x16x32_bf16 v[44:47], v[64:67], v[96:99], v[44:47]
    v_mfma_f32_16x16x32_bf16 v[40:43], v[68:71], v[96:99], v[40:43]
    v_mfma_f32_16x16x32_bf16 v[44:47], v[68:71], v[100:103], v[44:47]
    s_waitcnt lgkmcnt(0)
    v_mfma_f32_16x16x32_bf16 v[36:39], v[72:75], v[96:99], v[36:39]
    v_mfma_f32_16x16x32_bf16 v[40:43], v[72:75], v[100:103], v[40:43]
    v_mfma_f32_16x16x32_bf16 v[44:47], v[72:75], v[104:107], v[44:47]
    v_mfma_f32_16x16x32_bf16 v[32:35], v[76:79], v[96:99], v[32:35]
    v_mfma_f32_16x16x32_bf16 v[36:39], v[76:79], v[100:103], v[36:39]
    v_mfma_f32_16x16x32_bf16 v[40:43], v[76:79], v[104:107], v[40:43]
    v_mfma_f32_16x16x32_bf16 v[44:47], v[76:79], v[108:111], v[44:47]
C_le:
    s_setprio 3
    s_lshl_b32 s18, s30, 1
    v_add_u32 v112, s18, v3
    s_lshr_b32 s18, s16, 1
    s_add_u32 s17, s17, s18
    s_mul_i32 s18, s18, 16896
    s_lshl_b32 s19, s27, 10
    s_add_u32 s18, s18, s19
    v_add_u32 v113, s18, v3
    s_lshl_b32 s18, s22, 1
    v_add_u32 v114, s18, v113
    v_add_u32 v115, s18, v114
    v_add_u32 v116, s18, v115
    s_xor_b32 s18, s26, 1
    s_lshl_b32 s18, s18, 1
    s_add_u32 s18, s18, s27
    s_mul_i32 s36, s18, 160
    s_add_u32 s36, s36, s17
    s_and_b32 s37, s36, 1
    s_mul_i32 s37, s37, 60
    s_lshl_b32 s36, s36, 6
    s_sub_u32 s36, s36, s37
    s_add_u32 s36, s36, 28377088
    s_mul_i32 s18, s18, 655360
    s_lshl_b32 s19, s17, 7
    s_add_u32 s18, s18, s19
    s_add_u32 s18, s18, 24117248
    s_cmp_eq_u32 s26, 1
    s_cbranch_scc1 C_s2
    s_branch C_j2
C_s2:
    v_cvt_pk_bf16_f32 v56, v32, v33
    v_cvt_pk_bf16_f32 v57, v34, v35
    v_cvt_pk_bf16_f32 v58, v36, v37
    v_cvt_pk_bf16_f32 v59, v38, v39
    ds_write_b128 v112, v[56:59] offset:16896
    v_cvt_pk_bf16_f32 v60, v40, v41
    v_cvt_pk_bf16_f32 v61, v42, v43
    v_cvt_pk_bf16_f32 v62, v44, v45
    v_cvt_pk_bf16_f32 v63, v46, v47
    ds_write_b128 v112, v[60:63] offset:17920
C_j2:
    v_cvt_pk_bf16_f32 v48, v16, v17
    v_cvt_pk_bf16_f32 v49, v18, v19
    v_cvt_pk_bf16_f32 v50, v20, v21
    v_cvt_pk_bf16_f32 v51, v22, v23
    ds_write_b128 v112, v[48:51] offset:0
    v_cvt_pk_bf16_f32 v52, v24, v25
    v_cvt_pk_bf16_f32 v53, v26, v27
    v_cvt_pk_bf16_f32 v54, v28, v29
    v_cvt_pk_bf16_f32 v55, v30, v31
    ds_write_b128 v112, v[52:55] offset:1024
    s_lshl_b32 s19, s26, 1
    s_add_u32 s19, s19, 2
    s_cmp_ge_u32 s16, s19
    s_waitcnt lgkmcnt(0)
    s_barrier
    s_cbranch_scc1 C_hi2
    ds_read_b128 v[80:83], v113
    ds_read_b128 v[84:87], v114
    ds_read_b128 v[88:91], v115
    ds_read_b128 v[92:95], v116
    v_lshrrev_b32 v7, 3, v2
    v_mul_u32_u24 v7, 20352, v7
    v_add_u32 v7, v7, v3
    s_waitcnt lgkmcnt(0)
    s_barrier
    v_perm_b32 v16, v84, v80, s20
    v_perm_b32 v17, v92, v88, s20
    v_perm_b32 v18, v84, v80, s21
    v_perm_b32 v19, v92, v88, s21
    s_add_u32 s19, s18, 0
    buffer_store_dwordx4 v[16:19], v7, s[8:11], s19 offen sc1
    v_perm_b32 v20, v85, v81, s20
    v_perm_b32 v21, v93, v89, s20
    v_perm_b32 v22, v85, v81, s21
    v_perm_b32 v23, v93, v89, s21
    s_add_u32 s19, s18, 163840
    buffer_store_dwordx4 v[20:23], v7, s[8:11], s19 offen sc1
    v_perm_b32 v24, v86, v82, s20
    v_perm_b32 v25, v94, v90, s20
    v_perm_b32 v26, v86, v82, s21
    v_perm_b32 v27, v94, v90, s21
    s_add_u32 s19, s18, 327680
    buffer_store_dwordx4 v[24:27], v7, s[8:11], s19 offen sc1
    v_perm_b32 v28, v87, v83, s20
    v_perm_b32 v29, v95, v91, s20
    v_perm_b32 v30, v87, v83, s21
    v_perm_b32 v31, v95, v91, s21
    s_add_u32 s19, s18, 491520
    buffer_store_dwordx4 v[28:31], v7, s[8:11], s19 offen sc1
    s_mov_b64 exec, 1
    v_mov_b32 v7, 1
    s_waitcnt vmcnt(0)
    buffer_store_dword v7, off, s[8:11], s36 sc1
    s_mov_b64 exec, -1
    s_branch P_w
C_hi:
    s_cmp_lt_u32 s16, 4
    s_cbranch_scc1 P_w
    s_setprio 0
    s_bfe_u32 s18, s2, 0x30005
    s_mul_i32 s18, s18, 102400
    s_add_u32 s18, s18, 13631488
    s_add_u32 s18, s18, 92160
    buffer_load_dwordx4 v[76:79], v3, s[8:11], s18 offen offset:0
    buffer_load_dwordx4 v[80:83], v3, s[8:11], s18 offen offset:1024
    s_waitcnt vmcnt(1)
    buffer_load_dwordx4 v[84:87], v3, s[8:11], s18 offen offset:2048
    s_waitcnt vmcnt(1)
    buffer_load_dwordx4 v[88:91], v3, s[8:11], s18 offen offset:3072
    s_add_u32 s18, s18, 4096
    s_waitcnt vmcnt(1)
    buffer_load_dwordx4 v[92:95], v3, s[8:11], s18 offen offset:0
    s_waitcnt vmcnt(1)
    buffer_load_dwordx4 v[96:99], v3, s[8:11], s18 offen offset:1024
    s_waitcnt vmcnt(1)
    buffer_load_dwordx4 v[100:103], v3, s[8:11], s18 offen offset:2048
    s_waitcnt vmcnt(1)
    buffer_load_dwordx4 v[104:107], v3, s[8:11], s18 offen offset:3072
    s_add_u32 s18, s18, 4096
    s_waitcnt vmcnt(1)
    buffer_load_dwordx4 v[108:111], v3, s[8:11], s18 offen offset:0
    s_waitcnt vmcnt(1)
    buffer_load_dwordx4 v[112:115], v3, s[8:11], s18 offen offset:1024
    s_cmp_ge_u32 s2, 496
    s_cbranch_scc1 P_w
    s_barrier
C_hi2:
    s_barrier
P_w:
    s_setprio 3
    s_and_b32 s22, s2, 7
    s_lshl_b32 s22, s22, 2
    s_bfe_u32 s18, s2, 0x20003
    s_add_u32 s22, s22, s18
    s_bfe_u32 s23, s2, 0x30005
    s_lshr_b32 s24, s16, 2
    s_and_b32 s25, s16, 3
    s_mov_b32 s14, 5242880
    s_mov_b32 s15, 0x00020000
    s_lshl_b32 s18, s22, 1
    s_lshr_b32 s19, s25, 1
    s_add_u32 s18, s18, s19
    s_mul_i32 s26, s18, 40960
    s_add_u32 s26, s26, 10485760
    s_and_b32 s19, s25, 1
    s_lshl_b32 s19, s19, 4
    v_and_b32 v7, 15, v2
    v_lshrrev_b32 v1, 4, v2
    v_add_u32 v5, s19, v7
    v_lshlrev_b32 v6, 9, v1
    v_lshl_add_u32 v4, v5, 4, v6
    v_lshl_add_u32 v5, v5, 3, v6
    s_mul_i32 s18, s24, 40960
    v_add_u32 v6, s18, v3
    s_lshl_b32 s27, s24, 12
    s_add_u32 s27, s27, s26
    s_add_u32 s27, s27, 32768
    s_lshl_b32 s18, s24, 14
    s_add_u32 s26, s26, s18
    s_lshl_b32 s28, s22, 2
    s_add_u32 s28, s28, s25
    s_mul_i32 s28, s28, 40960
    s_mul_i32 s18, s23, 160
    s_add_u32 s28, s28, s18
    v_mul_u32_u24 v7, 2560, v7
    v_lshl_add_u32 v7, v1, 3, v7
    v_lshl_add_u32 v1, v1, 3, v7
    s_and_b32 s29, s25, 1
    s_mul_i32 s29, s29, 5120
    s_lshr_b32 s18, s25, 1
    s_mul_i32 s18, s18, 40960
    s_add_u32 s29, s29, s18
    s_mul_i32 s18, s23, 102400
    s_add_u32 s18, s18, 13631488
    s_cmp_eq_u32 s24, 0
    s_setprio 0
    s_cbranch_scc1 P_nd
    s_mul_i32 m0, s25, 20480
    s_add_u32 s18, s18, m0
    buffer_load_dwordx4 v3, s[8:11], s18 offen offset:0 lds
    buffer_load_dwordx4 v3, s[8:11], s18 offen offset:1024 lds
    buffer_load_dwordx4 v3, s[8:11], s18 offen offset:2048 lds
    buffer_load_dwordx4 v3, s[8:11], s18 offen offset:3072 lds
    s_add_u32 m0, m0, 4096
    s_add_u32 s18, s18, 4096
    s_waitcnt vmcnt(3)
    buffer_load_dwordx4 v3, s[8:11], s18 offen offset:0 lds
    s_waitcnt vmcnt(3)
    buffer_load_dwordx4 v3, s[8:11], s18 offen offset:1024 lds
    s_waitcnt vmcnt(3)
    buffer_load_dwordx4 v3, s[8:11], s18 offen offset:2048 lds
    s_waitcnt vmcnt(3)
    buffer_load_dwordx4 v3, s[8:11], s18 offen offset:3072 lds
    s_add_u32 m0, m0, 4096
    s_add_u32 s18, s18, 4096
    s_waitcnt vmcnt(3)
    buffer_load_dwordx4 v3, s[8:11], s18 offen offset:0 lds
    s_waitcnt vmcnt(3)
    buffer_load_dwordx4 v3, s[8:11], s18 offen offset:1024 lds
    s_waitcnt vmcnt(3)
    buffer_load_dwordx4 v3, s[8:11], s18 offen offset:2048 lds
    s_waitcnt vmcnt(3)
    buffer_load_dwordx4 v3, s[8:11], s18 offen offset:3072 lds
    s_add_u32 m0, m0, 4096
    s_add_u32 s18, s18, 4096
    s_waitcnt vmcnt(3)
    buffer_load_dwordx4 v3, s[8:11], s18 offen offset:0 lds
    s_waitcnt vmcnt(3)
    buffer_load_dwordx4 v3, s[8:11], s18 offen offset:1024 lds
    s_waitcnt vmcnt(3)
    buffer_load_dwordx4 v3, s[8:11], s18 offen offset:2048 lds
    s_waitcnt vmcnt(3)
    buffer_load_dwordx4 v3, s[8:11], s18 offen offset:3072 lds
    s_add_u32 m0, m0, 4096
    s_add_u32 s18, s18, 4096
    s_waitcnt vmcnt(3)
    buffer_load_dwordx4 v3, s[8:11], s18 offen offset:0 lds
    s_waitcnt vmcnt(3)
    buffer_load_dwordx4 v3, s[8:11], s18 offen offset:1024 lds
    s_waitcnt vmcnt(3)
    buffer_load_dwordx4 v3, s[8:11], s18 offen offset:2048 lds
    s_waitcnt vmcnt(3)
    buffer_load_dwordx4 v3, s[8:11], s18 offen offset:3072 lds
    s_branch P_nl
P_nd:
    s_add_u32 s18, s18, 81920
    buffer_load_dwordx4 v[76:79], v3, s[8:11], s18 offen offset:0
    buffer_load_dwordx4 v[80:83], v3, s[8:11], s18 offen offset:1024
    buffer_load_dwordx4 v[84:87], v3, s[8:11], s18 offen offset:2048
    s_waitcnt vmcnt(2)
    buffer_load_dwordx4 v[88:91], v3, s[8:11], s18 offen offset:3072
    s_add_u32 s18, s18, 4096
    s_waitcnt vmcnt(2)
    buffer_load_dwordx4 v[92:95], v3, s[8:11], s18 offen offset:0
    s_waitcnt vmcnt(2)
    buffer_load_dwordx4 v[96:99], v3, s[8:11], s18 offen offset:1024
    s_waitcnt vmcnt(2)
    buffer_load_dwordx4 v[100:103], v3, s[8:11], s18 offen offset:2048
    s_waitcnt vmcnt(2)
    buffer_load_dwordx4 v[104:107], v3, s[8:11], s18 offen offset:3072
    s_add_u32 s18, s18, 4096
    s_waitcnt vmcnt(2)
    buffer_load_dwordx4 v[108:111], v3, s[8:11], s18 offen offset:0
    s_waitcnt vmcnt(2)
    buffer_load_dwordx4 v[112:115], v3, s[8:11], s18 offen offset:1024
P_nl:
    s_waitcnt vmcnt(0)
    s_setprio 3
    s_cmp_eq_u32 s16, 4
    s_cbranch_scc0 P_n4
    s_and_b32 s18, s2, 7
    s_lshl_b32 s18, s18, 13
    s_add_u32 s18, s18, 28311552
    s_lshr_b32 s19, s2, 3
    v_add_u32 v20, s19, v2
    v_and_b32 v20, 31, v20
    v_lshlrev_b32 v20, 8, v20
    s_mov_b64 exec, 1
    s_mov_b32 s30, 0
P_a1:
    buffer_load_dword v16, v20, s[8:11], s18 offen sc1
    s_add_u32 s30, s30, 1
    s_cmp_ge_u32 s30, 65536
    s_waitcnt vmcnt(0)
    v_cmp_eq_u32 vcc, 0, v16
    s_cbranch_scc1 P_a1x
    s_nop 3
    s_cbranch_vccnz P_a1
P_a1x:
    s_mov_b64 exec, 0xffffffff
    s_setprio 3
    s_mov_b32 s30, 0
P_a2:
    buffer_load_dword v16, v20, s[8:11], s18 offen sc1
    s_add_u32 s30, s30, 1
    s_cmp_ge_u32 s30, 65536
    s_waitcnt vmcnt(0)
    v_cmp_eq_u32 vcc, 0, v16
    s_cbranch_scc1 P_a2x
    s_nop 3
    s_cbranch_vccz P_a2x
    s_mov_b64 exec, vcc
    s_branch P_a2
P_a2x:
    s_mov_b64 exec, -1
P_n4:
    s_cmp_eq_u32 s16, 3
    s_cbranch_scc0 P_n5
    s_bfe_u32 s18, s2, 0x20006
    s_lshl_b32 s18, s18, 1
    s_and_b32 s19, s2, 1
    s_add_u32 s18, s18, s19
    s_mul_i32 s18, s18, 5120
    s_add_u32 s18, s18, 28377088
    s_bfe_u32 s19, s2, 0x50001
    v_add_u32 v20, s19, v2
    v_subrev_u32 v21, 40, v20
    v_min_u32 v20, v20, v21
    v_lshlrev_b32 v20, 7, v20
    v_and_b32 v22, 7, v2
    v_lshrrev_b32 v23, 3, v2
    v_lshlrev_b32 v24, 8, v22
    v_lshl_add_u32 v24, v23, 3, v24
    v_bfe_u32 v25, v2, 3, 1
    v_bfe_u32 v23, v2, 4, 1
    v_lshl_add_u32 v25, v25, 1, v23
    v_lshrrev_b32 v23, 5, v2
    v_lshl_add_u32 v25, v23, 5, v25
    v_mul_u32_u24 v25, 2560, v25
    v_lshl_add_u32 v25, v22, 4, v25
    s_mul_i32 s31, s2, 10240
    s_add_u32 s31, s31, 21495808
    s_mov_b32 s30, 0
    s_mov_b32 vcc_lo, -1
    s_mov_b32 vcc_hi, 0xff
P_y:
    s_mov_b64 s[40:41], vcc
    s_ff1_i32_b64 s42, vcc
    s_lshl_b64 exec, 1, s42
P_yi:
    buffer_load_dwordx2 v[16:17], v20, s[8:11], s18 offen sc1
    s_add_u32 s30, s30, 1
    s_cmp_ge_u32 s30, 65536
    s_waitcnt vmcnt(0)
    v_min_u32 v16, v16, v17
    v_cmp_eq_u32 vcc, 0, v16
    s_cbranch_scc1 P_yx
    s_nop 3
    s_cbranch_vccnz P_yi
    s_andn2_b64 exec, s[40:41], exec
    s_cbranch_execz P_yx
    buffer_load_dwordx2 v[16:17], v20, s[8:11], s18 offen sc1
    s_waitcnt vmcnt(0)
    v_min_u32 v16, v16, v17
    v_cmp_eq_u32 vcc, 0, v16
    s_nop 4
    s_cbranch_vccnz P_y
P_yx:
    s_mov_b64 exec, -1
    s_setprio 3
    buffer_load_dwordx2 v[36:37], v24, s[8:11], s31 offen offset:0 sc1
    buffer_load_dwordx2 v[38:39], v24, s[8:11], s31 offen offset:128 sc1
    buffer_load_dwordx2 v[40:41], v24, s[8:11], s31 offen offset:64 sc1
    buffer_load_dwordx2 v[42:43], v24, s[8:11], s31 offen offset:192 sc1
    buffer_load_dwordx2 v[44:45], v24, s[8:11], s31 offen offset:2048 sc1
    buffer_load_dwordx2 v[46:47], v24, s[8:11], s31 offen offset:2176 sc1
    buffer_load_dwordx2 v[48:49], v24, s[8:11], s31 offen offset:2112 sc1
    buffer_load_dwordx2 v[50:51], v24, s[8:11], s31 offen offset:2240 sc1
    s_add_u32 s31, s31, 4096
    buffer_load_dwordx2 v[52:53], v24, s[8:11], s31 offen offset:0 sc1
    buffer_load_dwordx2 v[54:55], v24, s[8:11], s31 offen offset:128 sc1
    buffer_load_dwordx2 v[56:57], v24, s[8:11], s31 offen offset:64 sc1
    buffer_load_dwordx2 v[58:59], v24, s[8:11], s31 offen offset:192 sc1
    buffer_load_dwordx2 v[60:61], v24, s[8:11], s31 offen offset:2048 sc1
    buffer_load_dwordx2 v[62:63], v24, s[8:11], s31 offen offset:2176 sc1
    buffer_load_dwordx2 v[64:65], v24, s[8:11], s31 offen offset:2112 sc1
    buffer_load_dwordx2 v[66:67], v24, s[8:11], s31 offen offset:2240 sc1
    s_add_u32 s31, s31, 4096
    buffer_load_dwordx2 v[68:69], v24, s[8:11], s31 offen offset:0 sc1
    buffer_load_dwordx2 v[70:71], v24, s[8:11], s31 offen offset:128 sc1
    buffer_load_dwordx2 v[72:73], v24, s[8:11], s31 offen offset:64 sc1
    buffer_load_dwordx2 v[74:75], v24, s[8:11], s31 offen offset:192 sc1
    s_bfe_u32 s18, s2, 0x30005
    s_lshl_b32 s18, s18, 8
    s_bfe_u32 s19, s2, 0x10004
    s_lshl_b32 s19, s19, 2
    s_add_u32 s18, s18, s19
    s_bfe_u32 s19, s2, 0x10001
    s_lshl_b32 s19, s19, 7
    s_add_u32 s18, s18, s19
    s_bfe_u32 s19, s2, 0x20002
    s_lshl_b32 s19, s19, 3
    s_add_u32 s18, s18, s19
    s_mul_i32 s18, s18, 2560
    s_and_b32 s19, s2, 1
    s_mul_i32 s19, s19, 640
    s_add_u32 s18, s18, s19
    s_add_u32 s18, s18, 1280
    s_add_u32 s19, s18, 163840
    s_waitcnt vmcnt(18)
    buffer_store_dwordx4 v[36:39], v25, s[12:15], s18 offen offset:0 sc1
    s_waitcnt vmcnt(17)
    buffer_store_dwordx4 v[40:43], v25, s[12:15], s19 offen offset:0 sc1
    s_waitcnt vmcnt(16)
    buffer_store_dwordx4 v[44:47], v25, s[12:15], s18 offen offset:128 sc1
    s_waitcnt vmcnt(15)
    buffer_store_dwordx4 v[48:51], v25, s[12:15], s19 offen offset:128 sc1
    s_waitcnt vmcnt(14)
    buffer_store_dwordx4 v[52:55], v25, s[12:15], s18 offen offset:256 sc1
    s_waitcnt vmcnt(13)
    buffer_store_dwordx4 v[56:59], v25, s[12:15], s19 offen offset:256 sc1
    s_waitcnt vmcnt(12)
    buffer_store_dwordx4 v[60:63], v25, s[12:15], s18 offen offset:384 sc1
    s_waitcnt vmcnt(11)
    buffer_store_dwordx4 v[64:67], v25, s[12:15], s19 offen offset:384 sc1
    s_waitcnt vmcnt(10)
    buffer_store_dwordx4 v[68:71], v25, s[12:15], s18 offen offset:512 sc1
    s_waitcnt vmcnt(9)
    buffer_store_dwordx4 v[72:75], v25, s[12:15], s19 offen offset:512 sc1
    s_waitcnt vmcnt(0)
P_n5:
    s_setprio 3
    s_barrier
    buffer_load_dwordx2 v[36:37], v5, s[8:11], s27 offen offset:0 sc1
    buffer_load_dwordx2 v[38:39], v5, s[8:11], s27 offen offset:256 sc1
    buffer_load_dwordx2 v[40:41], v5, s[8:11], s27 offen offset:2048 sc1
    buffer_load_dwordx2 v[42:43], v5, s[8:11], s27 offen offset:2304 sc1
    buffer_load_dwordx4 v[44:47], v4, s[8:11], s26 offen offset:0 sc1
    buffer_load_dwordx4 v[48:51], v4, s[8:11], s26 offen offset:2048 sc1
    s_add_u32 s26, s26, 4096
    buffer_load_dwordx4 v[52:55], v4, s[8:11], s26 offen offset:0 sc1
    buffer_load_dwordx4 v[56:59], v4, s[8:11], s26 offen offset:2048 sc1
    s_add_u32 s26, s26, 4096
    buffer_load_dwordx4 v[60:63], v4, s[8:11], s26 offen offset:0 sc1
    buffer_load_dwordx4 v[64:67], v4, s[8:11], s26 offen offset:2048 sc1
    s_add_u32 s26, s26, 4096
    buffer_load_dwordx4 v[68:71], v4, s[8:11], s26 offen offset:0 sc1
    buffer_load_dwordx4 v[72:75], v4, s[8:11], s26 offen offset:2048 sc1
    ds_read_b128 v[116:119], v6 offset:0
    ds_read_b128 v[120:123], v6 offset:1024
    ds_read_b128 v[124:127], v6 offset:2048
    ds_read_b128 v[8:11], v6 offset:3072
    ds_read_b128 v[12:15], v6 offset:4096
    v_add_u32 v4, s29, v3
    v_and_b32 v3, 3, v2
    v_lshrrev_b32 v7, 2, v2
    v_mul_u32_u24 v7, 2560, v7
    v_lshl_add_u32 v7, v3, 3, v7
    v_lshl_add_u32 v1, v3, 3, v7
    v_and_b32 v2, 60, v2
    v_lshl_add_u32 v2, v3, 6, v2
    s_waitcnt vmcnt(10)
    v_mfma_f32_16x16x32_bf16 v[16:19], v[76:79], v[36:39], 0
    ds_read_b128 v[76:79], v6 offset:5120
    v_mfma_f32_16x16x32_bf16 v[20:23], v[80:83], v[36:39], 0
    ds_read_b128 v[80:83], v6 offset:6144
    v_mfma_f32_16x16x32_bf16 v[24:27], v[84:87], v[36:39], 0
    ds_read_b128 v[84:87], v6 offset:7168
    v_mfma_f32_16x16x32_bf16 v[28:31], v[88:91], v[36:39], 0
    ds_read_b128 v[88:91], v6 offset:8192
    v_mfma_f32_16x16x32_bf16 v[32:35], v[92:95], v[36:39], 0
    ds_read_b128 v[92:95], v6 offset:9216
    s_waitcnt vmcnt(8)
    v_mfma_f32_16x16x32_bf16 v[16:19], v[96:99], v[40:43], v[16:19]
    ds_read_b128 v[96:99], v6 offset:10240
    v_mfma_f32_16x16x32_bf16 v[20:23], v[100:103], v[40:43], v[20:23]
    ds_read_b128 v[100:103], v6 offset:11264
    v_mfma_f32_16x16x32_bf16 v[24:27], v[104:107], v[40:43], v[24:27]
    ds_read_b128 v[104:107], v6 offset:12288
    v_mfma_f32_16x16x32_bf16 v[28:31], v[108:111], v[40:43], v[28:31]
    ds_read_b128 v[108:111], v6 offset:13312
    v_mfma_f32_16x16x32_bf16 v[32:35], v[112:115], v[40:43], v[32:35]
    ds_read_b128 v[112:115], v6 offset:14336
    s_waitcnt vmcnt(7) lgkmcnt(14)
    v_mfma_f32_16x16x32_bf16 v[16:19], v[116:119], v[44:47], v[16:19]
    ds_read_b128 v[116:119], v6 offset:15360
    s_waitcnt lgkmcnt(14)
    v_mfma_f32_16x16x32_bf16 v[20:23], v[120:123], v[44:47], v[20:23]
    ds_read_b128 v[120:123], v6 offset:16384
    s_waitcnt lgkmcnt(14)
    v_mfma_f32_16x16x32_bf16 v[24:27], v[124:127], v[44:47], v[24:27]
    ds_read_b128 v[124:127], v6 offset:17408
    s_waitcnt lgkmcnt(14)
    v_mfma_f32_16x16x32_bf16 v[28:31], v[8:11], v[44:47], v[28:31]
    ds_read_b128 v[8:11], v6 offset:18432
    s_waitcnt lgkmcnt(14)
    v_mfma_f32_16x16x32_bf16 v[32:35], v[12:15], v[44:47], v[32:35]
    ds_read_b128 v[12:15], v6 offset:19456
    s_waitcnt vmcnt(6) lgkmcnt(14)
    v_mfma_f32_16x16x32_bf16 v[16:19], v[76:79], v[48:51], v[16:19]
    ds_read_b128 v[76:79], v6 offset:20480
    s_waitcnt lgkmcnt(14)
    v_mfma_f32_16x16x32_bf16 v[20:23], v[80:83], v[48:51], v[20:23]
    ds_read_b128 v[80:83], v6 offset:21504
    s_waitcnt lgkmcnt(14)
    v_mfma_f32_16x16x32_bf16 v[24:27], v[84:87], v[48:51], v[24:27]
    ds_read_b128 v[84:87], v6 offset:22528
    s_waitcnt lgkmcnt(14)
    v_mfma_f32_16x16x32_bf16 v[28:31], v[88:91], v[48:51], v[28:31]
    ds_read_b128 v[88:91], v6 offset:23552
    s_waitcnt lgkmcnt(14)
    v_mfma_f32_16x16x32_bf16 v[32:35], v[92:95], v[48:51], v[32:35]
    ds_read_b128 v[92:95], v6 offset:24576
    s_waitcnt vmcnt(5) lgkmcnt(14)
    v_mfma_f32_16x16x32_bf16 v[16:19], v[96:99], v[52:55], v[16:19]
    ds_read_b128 v[96:99], v6 offset:25600
    s_waitcnt lgkmcnt(14)
    v_mfma_f32_16x16x32_bf16 v[20:23], v[100:103], v[52:55], v[20:23]
    ds_read_b128 v[100:103], v6 offset:26624
    s_waitcnt lgkmcnt(14)
    v_mfma_f32_16x16x32_bf16 v[24:27], v[104:107], v[52:55], v[24:27]
    ds_read_b128 v[104:107], v6 offset:27648
    s_waitcnt lgkmcnt(14)
    v_mfma_f32_16x16x32_bf16 v[28:31], v[108:111], v[52:55], v[28:31]
    ds_read_b128 v[108:111], v6 offset:28672
    s_waitcnt lgkmcnt(14)
    v_mfma_f32_16x16x32_bf16 v[32:35], v[112:115], v[52:55], v[32:35]
    ds_read_b128 v[112:115], v6 offset:29696
    s_waitcnt vmcnt(4) lgkmcnt(14)
    v_mfma_f32_16x16x32_bf16 v[16:19], v[116:119], v[56:59], v[16:19]
    ds_read_b128 v[116:119], v6 offset:30720
    s_waitcnt lgkmcnt(14)
    v_mfma_f32_16x16x32_bf16 v[20:23], v[120:123], v[56:59], v[20:23]
    ds_read_b128 v[120:123], v6 offset:31744
    s_waitcnt lgkmcnt(14)
    v_mfma_f32_16x16x32_bf16 v[24:27], v[124:127], v[56:59], v[24:27]
    ds_read_b128 v[124:127], v6 offset:32768
    s_waitcnt lgkmcnt(14)
    v_mfma_f32_16x16x32_bf16 v[28:31], v[8:11], v[56:59], v[28:31]
    ds_read_b128 v[8:11], v6 offset:33792
    s_waitcnt lgkmcnt(14)
    v_mfma_f32_16x16x32_bf16 v[32:35], v[12:15], v[56:59], v[32:35]
    ds_read_b128 v[12:15], v6 offset:34816
    s_waitcnt vmcnt(3) lgkmcnt(14)
    v_mfma_f32_16x16x32_bf16 v[16:19], v[76:79], v[60:63], v[16:19]
    ds_read_b128 v[76:79], v6 offset:35840
    s_waitcnt lgkmcnt(14)
    v_mfma_f32_16x16x32_bf16 v[20:23], v[80:83], v[60:63], v[20:23]
    ds_read_b128 v[80:83], v6 offset:36864
    s_waitcnt lgkmcnt(14)
    v_mfma_f32_16x16x32_bf16 v[24:27], v[84:87], v[60:63], v[24:27]
    ds_read_b128 v[84:87], v6 offset:37888
    s_waitcnt lgkmcnt(14)
    v_mfma_f32_16x16x32_bf16 v[28:31], v[88:91], v[60:63], v[28:31]
    ds_read_b128 v[88:91], v6 offset:38912
    s_waitcnt lgkmcnt(14)
    v_mfma_f32_16x16x32_bf16 v[32:35], v[92:95], v[60:63], v[32:35]
    ds_read_b128 v[92:95], v6 offset:39936
    s_waitcnt vmcnt(2) lgkmcnt(14)
    v_mfma_f32_16x16x32_bf16 v[16:19], v[96:99], v[64:67], v[16:19]
    s_waitcnt lgkmcnt(13)
    v_mfma_f32_16x16x32_bf16 v[20:23], v[100:103], v[64:67], v[20:23]
    s_waitcnt lgkmcnt(12)
    v_mfma_f32_16x16x32_bf16 v[24:27], v[104:107], v[64:67], v[24:27]
    s_waitcnt lgkmcnt(11)
    v_mfma_f32_16x16x32_bf16 v[28:31], v[108:111], v[64:67], v[28:31]
    s_waitcnt lgkmcnt(10)
    v_mfma_f32_16x16x32_bf16 v[32:35], v[112:115], v[64:67], v[32:35]
    s_waitcnt vmcnt(1) lgkmcnt(9)
    v_mfma_f32_16x16x32_bf16 v[16:19], v[116:119], v[68:71], v[16:19]
    s_waitcnt lgkmcnt(8)
    v_mfma_f32_16x16x32_bf16 v[20:23], v[120:123], v[68:71], v[20:23]
    s_waitcnt lgkmcnt(7)
    v_mfma_f32_16x16x32_bf16 v[24:27], v[124:127], v[68:71], v[24:27]
    s_waitcnt lgkmcnt(6)
    v_mfma_f32_16x16x32_bf16 v[28:31], v[8:11], v[68:71], v[28:31]
    s_waitcnt lgkmcnt(5)
    v_mfma_f32_16x16x32_bf16 v[32:35], v[12:15], v[68:71], v[32:35]
    s_barrier
    s_waitcnt vmcnt(0) lgkmcnt(4)
    v_mfma_f32_16x16x32_bf16 v[16:19], v[76:79], v[72:75], v[16:19]
    s_waitcnt lgkmcnt(3)
    v_mfma_f32_16x16x32_bf16 v[20:23], v[80:83], v[72:75], v[20:23]
    s_waitcnt lgkmcnt(2)
    v_mfma_f32_16x16x32_bf16 v[24:27], v[84:87], v[72:75], v[24:27]
    s_waitcnt lgkmcnt(1)
    v_mfma_f32_16x16x32_bf16 v[28:31], v[88:91], v[72:75], v[28:31]
    s_waitcnt lgkmcnt(0)
    v_mfma_f32_16x16x32_bf16 v[32:35], v[92:95], v[72:75], v[32:35]
    s_cmp_eq_u32 s24, 0
    s_cbranch_scc0 P_k1
    s_nop 1
    ds_write_b128 v4, v[24:27] offset:2048
    s_nop 0
    ds_write_b128 v4, v[28:31] offset:3072
    s_waitcnt lgkmcnt(0)
    s_barrier
    ds_read_b128 v[36:39], v4 offset:0
    ds_read_b128 v[40:43], v4 offset:1024
    ds_read_b128 v[52:55], v4 offset:4096
    s_waitcnt lgkmcnt(2)
    v_add_f32 v16, v16, v36
    v_add_f32 v17, v17, v37
    v_add_f32 v18, v18, v38
    v_add_f32 v19, v19, v39
    v_cvt_pk_bf16_f32 v76, v16, v17
    v_cvt_pk_bf16_f32 v77, v18, v19
    ds_bpermute_b32 v84, v2, v76
    ds_bpermute_b32 v85, v2, v77
    s_waitcnt lgkmcnt(3)
    v_add_f32 v20, v20, v40
    v_add_f32 v21, v21, v41
    v_add_f32 v22, v22, v42
    v_add_f32 v23, v23, v43
    v_cvt_pk_bf16_f32 v78, v20, v21
    v_cvt_pk_bf16_f32 v79, v22, v23
    ds_bpermute_b32 v86, v2, v78
    ds_bpermute_b32 v87, v2, v79
    s_waitcnt lgkmcnt(4)
    v_add_f32 v32, v32, v52
    v_add_f32 v33, v33, v53
    v_add_f32 v34, v34, v54
    v_add_f32 v35, v35, v55
    v_cvt_pk_bf16_f32 v80, v32, v33
    v_cvt_pk_bf16_f32 v81, v34, v35
    ds_bpermute_b32 v88, v2, v80
    ds_bpermute_b32 v89, v2, v81
    s_waitcnt lgkmcnt(2)
    buffer_store_dwordx4 v[84:87], v1, s[12:15], s28 offen offset:0
    s_waitcnt lgkmcnt(0)
    buffer_store_dwordx2 v[88:89], v7, s[12:15], s28 offen offset:128
    s_branch P_end
P_k1:
    ds_write_b128 v4, v[16:19] offset:0
    ds_write_b128 v4, v[20:23] offset:1024
    s_nop 3
    ds_write_b128 v4, v[32:35] offset:4096
    s_waitcnt lgkmcnt(0)
    s_barrier
    ds_read_b128 v[44:47], v4 offset:2048
    ds_read_b128 v[48:51], v4 offset:3072
    s_waitcnt lgkmcnt(1)
    v_add_f32 v24, v24, v44
    v_add_f32 v25, v25, v45
    v_add_f32 v26, v26, v46
    v_add_f32 v27, v27, v47
    v_cvt_pk_bf16_f32 v76, v24, v25
    v_cvt_pk_bf16_f32 v77, v26, v27
    ds_bpermute_b32 v84, v2, v76
    ds_bpermute_b32 v85, v2, v77
    s_waitcnt lgkmcnt(2)
    v_add_f32 v28, v28, v48
    v_add_f32 v29, v29, v49
    v_add_f32 v30, v30, v50
    v_add_f32 v31, v31, v51
    v_cvt_pk_bf16_f32 v78, v28, v29
    v_cvt_pk_bf16_f32 v79, v30, v31
    ds_bpermute_b32 v86, v2, v78
    ds_bpermute_b32 v87, v2, v79
    s_waitcnt lgkmcnt(0)
    buffer_store_dwordx4 v[84:87], v1, s[12:15], s28 offen offset:64
P_end:
C_exit:
    s_endpgm
.section .rodata,"a"
.p2align 6
.amdhsa_kernel k1_kernel
  .amdhsa_next_free_vgpr 256
  .amdhsa_next_free_sgpr 102
  .amdhsa_accum_offset 256
  .amdhsa_group_segment_fixed_size 0
  .amdhsa_kernarg_size 120
  .amdhsa_user_sgpr_count 2
  .amdhsa_user_sgpr_kernarg_segment_ptr 1
  .amdhsa_system_sgpr_workgroup_id_x 1
.end_amdhsa_kernel
.p2align 6
.amdhsa_kernel k2_kernel
  .amdhsa_next_free_vgpr 128
  .amdhsa_next_free_sgpr 102
  .amdhsa_accum_offset 128
  .amdhsa_group_segment_fixed_size 0
  .amdhsa_kernarg_size 120
  .amdhsa_user_sgpr_count 2
  .amdhsa_user_sgpr_kernarg_segment_ptr 1
  .amdhsa_system_sgpr_workgroup_id_x 1
.end_amdhsa_kernel
```
